```python
import torch

def _softmax(x, axis=-1):
    return torch.softmax(x, dim=axis)

def _gelu(x):
    return torch.nn.functional.gelu(x, approximate='tanh')

def _silu(x):
    return torch.nn.functional.silu(x)

def _sigmoid(x):
    return torch.sigmoid(x)

def _layernorm(x, axis=-1, eps=1e-05):
    m = x.mean(dim=axis, keepdim=True)
    v = x.var(dim=axis, keepdim=True, unbiased=False)
    return (x - m) / torch.sqrt(v + eps)

def _scatter_add(tgt, idx, src, axis=0):
    return tgt.clone().index_add_(axis, idx, src)

def _segment_sum(src, seg, n):
    out = torch.zeros((n,) + src.shape[1:], dtype=src.dtype)
    return out.index_add_(0, seg, src)

def _pad(x, pw):
    flat = tuple((v for pair in reversed(pw) for v in pair))
    return torch.nn.functional.pad(x, flat)
kernel_name = 'parallel_sum__linear_attn_block__mixer_gmlp__prompt'

def setup_inputs():

    _w = lambda a: (lambda t: t.to(torch.bfloat16) if t.is_floating_point() else t)(torch.as_tensor(a))

    def _A_setup():
        B, S, D = (1, 2048, 640)
        return {'x': _w((lambda *s: torch.randn(*s, dtype=torch.bfloat16) * 0.05)(B, S, D)), 'wqkv': _w((lambda *s: torch.randn(*s, dtype=torch.bfloat16) * 0.8)(D, 3 * D)), 'wo': _w((lambda *s: torch.randn(*s, dtype=torch.bfloat16) * 0.2)(D, D))}
    _A_in = _A_setup()

    def _B_setup():
        B, S, D, F = (1, 2048, 640, 1728)
        Fh = F // 2
        return {'x': _w((lambda *s: torch.randn(*s, dtype=torch.bfloat16) * 0.05)(B, S, D)), 'w_in': _w((lambda *s: torch.randn(*s, dtype=torch.bfloat16) * 0.4)(D, 2 * Fh)), 'w_sp': _w(0.01 * (lambda *s: torch.randn(*s, dtype=torch.bfloat16) * 0.4)(S, S)), 'b_sp': _w(1.0 + 0.01 * (lambda *s: torch.randn(*s, dtype=torch.bfloat16) * 0.05)(S)), 'w_out': _w((lambda *s: torch.randn(*s, dtype=torch.bfloat16) * 0.05)(Fh, D))}
    _B_in = _B_setup()
    return {'A_x': _A_in['x'], 'A_wqkv': _A_in['wqkv'], 'A_wo': _A_in['wo'], 'B_x': _B_in['x'], 'B_w_in': _B_in['w_in'], 'B_w_sp': _B_in['w_sp'], 'B_b_sp': _B_in['b_sp'], 'B_w_out': _B_in['w_out']}

def reference(A_x, A_wqkv, A_wo, B_x, B_w_in, B_w_sp, B_b_sp, B_w_out):

    def _A_ref(x, wqkv, wo):
        B, S, D = x.shape
        H = 32
        Dh = D // H
        qkv = (lambda x, *d: x.permute(*d))((x @ wqkv).reshape(B, S, 3, H, Dh), 2, 0, 3, 1, 4)
        q, k, v = (qkv[0], qkv[1], qkv[2])
        phi = lambda t: torch.where(t > 0, t + 1, torch.exp(t)) + 1e-06
        pq, pk = (phi(q), phi(k))
        kv = torch.einsum('bhsd,bhse->bhde', pk, v)
        z = torch.einsum('bhsd->bhd', pk)
        num = torch.einsum('bhqd,bhde->bhqe', pq, kv)
        den = torch.einsum('bhqd,bhd->bhq', pq, z)[..., None] + 1e-06
        o = num / den
        return (lambda x, *d: x.permute(*d))(o, 0, 2, 1, 3).reshape(B, S, D) @ wo

    def _B_ref(x, w_in, w_sp, b_sp, w_out):
        B, S, D = x.shape
        F = w_in.shape[-1]
        Fh = F // 2
        z = _gelu(torch.einsum('bsd,df->bsf', x, w_in))
        z1 = z[..., :Fh].clone()
        z2 = _layernorm(z[..., Fh:], axis=-1)
        g = torch.einsum('ts,bsf->btf', w_sp, z2) + b_sp[None, :, None]
        return torch.einsum('bsf,fd->bsd', z1 * g, w_out)
    x = A_x
    xn = _layernorm(x, axis=-1)
    return x + _A_ref(xn, A_wqkv, A_wo) + _B_ref(xn, B_w_in, B_w_sp, B_b_sp, B_w_out)
```

```asm
; @launch grid=(256,1,1) block=(768,1,1) lds=150848
.amdgcn_target "amdgcn-amd-amdhsa--gfx950"
.text
.p2align 8
.globl parallel_sum__linear_attn_block__mixer_gmlp__prompt_kernel
.type parallel_sum__linear_attn_block__mixer_gmlp__prompt_kernel,@function
parallel_sum__linear_attn_block__mixer_gmlp__prompt_kernel:
    s_cmp_ge_u32 s2, 256
    s_cbranch_scc1 parallel_sum__linear_attn_block__mixer_gmlp__prompt_kernel_end
    s_load_dwordx16 s[4:19], s[0:1], 0
    s_load_dwordx4 s[20:23], s[0:1], 64
    s_load_dwordx2 s[24:25], s[0:1], 80
    v_lshrrev_b32 v11, 6, v0
    v_and_b32 v6, 63, v0
    v_readfirstlane_b32 s44, v11
    s_and_b32 s49, s2, 7
    s_lshr_b32 s50, s2, 3
    s_lshr_b32 s47, s49, 2
    s_lshl_b32 s47, s47, 3
    s_lshr_b32 s51, s50, 2
    s_add_u32 s47, s47, s51
    s_and_b32 s48, s49, 3
    s_xor_b32 s48, s48, 0
    s_lshl_b32 s48, s48, 1
    s_and_b32 s51, s50, 1
    s_add_u32 s48, s48, s51
    s_and_b32 s51, s50, 2
    s_lshl_b32 s51, s51, 2
    s_add_u32 s48, s48, s51
    s_and_b32 s45, s44, 3
    s_lshr_b32 s46, s44, 2
    s_cmp_lg_u32 s46, 2
    s_cbranch_scc1 k1comp_2
    s_setprio 3
    v_lshrrev_b32 v11, 3, v6
    v_bfe_u32 v13, v6, 4, 1
    v_and_b32 v12, 7, v6
    v_xor_b32 v12, v12, v13
    s_lshl_b32 s49, s47, 7
    s_lshl_b32 s50, s45, 5
    s_add_u32 s49, s49, s50
    v_add_u32 v14, s49, v11
    v_mul_u32_u24 v14, 1280, v14
    v_xor_b32 v15, 0, v12
    v_lshl_add_u32 v44, v15, 4, v14
    v_xor_b32 v15, 2, v12
    v_lshl_add_u32 v45, v15, 4, v14
    v_add_u32 v45, 9216, v45
    v_xor_b32 v15, 4, v12
    v_lshl_add_u32 v46, v15, 4, v14
    v_add_u32 v46, 18432, v46
    v_xor_b32 v15, 6, v12
    v_lshl_add_u32 v47, v15, 4, v14
    v_add_u32 v47, 27648, v47
    s_lshl_b32 s62, s45, 12
    s_add_u32 s51, s47, s48
    s_mul_i32 s49, s51, 128
    s_lshr_b32 s49, s49, 8
    s_mul_i32 s49, s49, 2
    s_sub_u32 s51, s51, s49
    s_mul_i32 s51, s51, 5
    s_lshl_b32 s58, s51, 7
    s_waitcnt lgkmcnt(0)
    s_mov_b32 s28, s4
    s_mov_b32 s29, s5
    s_mov_b32 s30, 0x280000
    s_mov_b32 s31, 0x20000
    s_add_u32 m0, s62, 0
    s_nop 0
    buffer_load_dwordx4 v44, s[28:31], s58 offen offset:0 lds
    buffer_load_dwordx4 v45, s[28:31], s58 offen offset:1024 lds
    buffer_load_dwordx4 v46, s[28:31], s58 offen offset:2048 lds
    buffer_load_dwordx4 v47, s[28:31], s58 offen offset:3072 lds
    s_add_u32 s58, s58, 128
    s_cmp_eq_u32 s58, 1280
    s_cselect_b32 s58, 0, s58
    s_add_u32 s61, s62, 49152
    s_mov_b32 s53, 32
    s_mov_b32 s54, 4
    s_mov_b32 s56, 0
    s_cmp_ge_u32 s48, 8
    s_cbranch_scc1 k1lz_3
    s_lshl_b32 s52, s48, 7
    s_cmp_eq_u32 s45, 3
    s_cbranch_scc1 k1ld_4
    s_mul_i32 s52, s48, 160
    s_cmp_eq_u32 s45, 2
    s_cbranch_scc1 k1l2_5
    s_mul_i32 s49, s45, 1280
    s_add_u32 s52, s52, s49
    s_add_u32 s52, s52, 1280
    s_branch k1ld_4
k1l2_5:
    s_add_u32 s52, s52, 1408
    s_mov_b32 s53, 1280
    s_mov_b32 s54, 2
    s_branch k1ld_4
k1lz_3:
    s_sub_u32 s49, s48, 8
    s_lshl_b32 s49, s49, 1
    s_add_u32 s49, s49, s45
    s_mov_b32 s56, 1
    s_cmp_ge_u32 s45, 2
    s_cbranch_scc1 k1lz1_81
    s_add_u32 s49, s49, 13
    s_lshl_b32 s52, s49, 7
    s_cmp_eq_u32 s48, 15
    s_cselect_b32 s54, 0, 4
    s_branch k1ld_4
k1lz1_81:
    s_sub_u32 s49, s49, 2
    s_lshl_b32 s52, s49, 7
    s_cmp_lg_u32 s48, 15
    s_cbranch_scc1 k1ld_4
    s_mov_b32 s56, 0
    s_add_u32 s49, s45, 6
    s_lshl_b32 s52, s49, 7
k1ld_4:
    s_cmp_eq_u32 s56, 1
    s_movk_i32 s55, 3840
    s_cselect_b32 s55, 3456, s55
    s_cselect_b32 s32, s12, s6
    s_cselect_b32 s33, s13, s7
    s_mul_i32 s34, s55, 640
    s_mov_b32 s35, 0x20000
    s_lshl_b32 s60, s55, 5
    s_mul_i32 s59, s51, s60
    s_lshl_b32 s59, s59, 1
    v_bfe_u32 v12, v6, 1, 2
    v_xor_b32 v12, v12, v13
    v_and_b32 v14, 1, v6
    v_mul_lo_u32 v15, v11, s55
    v_lshl_add_u32 v15, v14, 4, v15
    v_add_u32 v15, s52, v15
    v_mov_b32 v16, 1073741824
    s_lshl_b32 s49, s55, 3
    s_sub_u32 s49, s49, 1024
    s_lshl_b32 s50, s49, 1
    v_mul_lo_u32 v14, v12, s53
    v_add_u32 v40, v14, v15
    v_cmp_gt_u32 vcc, s54, v12
    s_nop 1
    v_cndmask_b32 v40, v16, v40, vcc
    v_add_u32 v42, s50, v40
    v_xor_b32 v12, 2, v12
    v_add_u32 v15, s49, v15
    v_mul_lo_u32 v14, v12, s53
    v_add_u32 v41, v14, v15
    v_cmp_gt_u32 vcc, s54, v12
    s_nop 1
    v_cndmask_b32 v41, v16, v41, vcc
    v_add_u32 v43, s50, v41
    s_add_u32 m0, s61, 0
    s_nop 0
    buffer_load_dwordx4 v40, s[32:35], s59 offen offset:0 lds
    buffer_load_dwordx4 v41, s[32:35], s59 offen offset:1024 lds
    buffer_load_dwordx4 v42, s[32:35], s59 offen offset:2048 lds
    buffer_load_dwordx4 v43, s[32:35], s59 offen offset:3072 lds
    s_add_u32 s59, s59, s60
    s_cmp_eq_u32 s59, s34
    s_cselect_b32 s59, 0, s59
    s_add_u32 m0, s61, 16384
    s_nop 0
    buffer_load_dwordx4 v40, s[32:35], s59 offen offset:0 lds
    buffer_load_dwordx4 v41, s[32:35], s59 offen offset:1024 lds
    buffer_load_dwordx4 v42, s[32:35], s59 offen offset:2048 lds
    buffer_load_dwordx4 v43, s[32:35], s59 offen offset:3072 lds
    s_add_u32 s59, s59, s60
    s_cmp_eq_u32 s59, s34
    s_cselect_b32 s59, 0, s59
    s_add_u32 m0, s61, 32768
    s_nop 0
    buffer_load_dwordx4 v40, s[32:35], s59 offen offset:0 lds
    buffer_load_dwordx4 v41, s[32:35], s59 offen offset:1024 lds
    buffer_load_dwordx4 v42, s[32:35], s59 offen offset:2048 lds
    buffer_load_dwordx4 v43, s[32:35], s59 offen offset:3072 lds
    s_add_u32 s59, s59, s60
    s_cmp_eq_u32 s59, s34
    s_cselect_b32 s59, 0, s59
    s_add_u32 m0, s62, 16384
    s_nop 0
    buffer_load_dwordx4 v44, s[28:31], s58 offen offset:0 lds
    buffer_load_dwordx4 v45, s[28:31], s58 offen offset:1024 lds
    buffer_load_dwordx4 v46, s[28:31], s58 offen offset:2048 lds
    buffer_load_dwordx4 v47, s[28:31], s58 offen offset:3072 lds
    s_add_u32 s58, s58, 128
    s_cmp_eq_u32 s58, 1280
    s_cselect_b32 s58, 0, s58
    s_add_u32 m0, s61, 49152
    s_nop 0
    buffer_load_dwordx4 v40, s[32:35], s59 offen offset:0 lds
    buffer_load_dwordx4 v41, s[32:35], s59 offen offset:1024 lds
    buffer_load_dwordx4 v42, s[32:35], s59 offen offset:2048 lds
    buffer_load_dwordx4 v43, s[32:35], s59 offen offset:3072 lds
    s_add_u32 s59, s59, s60
    s_cmp_eq_u32 s59, s34
    s_cselect_b32 s59, 0, s59
    s_waitcnt vmcnt(12)
    s_barrier
    s_add_u32 m0, s61, 65536
    s_nop 0
    buffer_load_dwordx4 v40, s[32:35], s59 offen offset:0 lds
    buffer_load_dwordx4 v41, s[32:35], s59 offen offset:1024 lds
    buffer_load_dwordx4 v42, s[32:35], s59 offen offset:2048 lds
    buffer_load_dwordx4 v43, s[32:35], s59 offen offset:3072 lds
    s_add_u32 s59, s59, s60
    s_cmp_eq_u32 s59, s34
    s_cselect_b32 s59, 0, s59
    s_add_u32 m0, s62, 32768
    s_nop 0
    buffer_load_dwordx4 v44, s[28:31], s58 offen offset:0 lds
    buffer_load_dwordx4 v45, s[28:31], s58 offen offset:1024 lds
    buffer_load_dwordx4 v46, s[28:31], s58 offen offset:2048 lds
    buffer_load_dwordx4 v47, s[28:31], s58 offen offset:3072 lds
    s_add_u32 s58, s58, 128
    s_cmp_eq_u32 s58, 1280
    s_cselect_b32 s58, 0, s58
    s_add_u32 m0, s61, 81920
    s_nop 0
    buffer_load_dwordx4 v40, s[32:35], s59 offen offset:0 lds
    buffer_load_dwordx4 v41, s[32:35], s59 offen offset:1024 lds
    buffer_load_dwordx4 v42, s[32:35], s59 offen offset:2048 lds
    buffer_load_dwordx4 v43, s[32:35], s59 offen offset:3072 lds
    s_add_u32 s59, s59, s60
    s_cmp_eq_u32 s59, s34
    s_cselect_b32 s59, 0, s59
    s_mov_b32 s36, s22
    s_mov_b32 s37, s23
    s_mov_b32 s38, 0x100
    s_mov_b32 s39, 0x20000
    s_add_u32 s80, s24, 0xb50000
    s_addc_u32 s81, s25, 0
    s_mov_b32 s82, 0x6c000
    s_mov_b32 s83, 0x20000
    v_lshlrev_b32 v154, 2, v6
    s_lshl_b32 s49, s48, 4
    s_lshl_b32 s50, s47, 4
    v_mov_b32 v152, s49
    v_mov_b32 v11, s50
    v_cmp_gt_u32 vcc, 32, v6
    s_nop 1
    v_cndmask_b32 v152, v152, v11, vcc
    v_cmp_lt_u32 vcc, 15, v6
    s_nop 1
    v_cndmask_b32 v152, 0, v152, vcc
    v_and_b32 v105, 127, v0
    v_lshlrev_b32 v104, 2, v105
    v_lshlrev_b32 v105, 3, v105
    s_bfe_u32 s71, s2, 0x20005
    s_cmp_lg_u32 s45, 0
    s_cselect_b32 s71, 99, s71
    s_mov_b32 s63, 0
    s_waitcnt vmcnt(12)
    s_barrier
    s_add_u32 m0, s61, 0
    s_nop 0
    buffer_load_dwordx4 v40, s[32:35], s59 offen offset:0 lds
    buffer_load_dwordx4 v41, s[32:35], s59 offen offset:1024 lds
    buffer_load_dwordx4 v42, s[32:35], s59 offen offset:2048 lds
    buffer_load_dwordx4 v43, s[32:35], s59 offen offset:3072 lds
    s_add_u32 s59, s59, s60
    s_cmp_eq_u32 s59, s34
    s_cselect_b32 s59, 0, s59
    s_add_u32 m0, s62, 0
    s_nop 0
    buffer_load_dwordx4 v44, s[28:31], s58 offen offset:0 lds
    buffer_load_dwordx4 v45, s[28:31], s58 offen offset:1024 lds
    buffer_load_dwordx4 v46, s[28:31], s58 offen offset:2048 lds
    buffer_load_dwordx4 v47, s[28:31], s58 offen offset:3072 lds
    s_add_u32 s58, s58, 128
    s_cmp_eq_u32 s58, 1280
    s_cselect_b32 s58, 0, s58
    s_add_u32 m0, s61, 16384
    s_nop 0
    buffer_load_dwordx4 v40, s[32:35], s59 offen offset:0 lds
    buffer_load_dwordx4 v41, s[32:35], s59 offen offset:1024 lds
    buffer_load_dwordx4 v42, s[32:35], s59 offen offset:2048 lds
    buffer_load_dwordx4 v43, s[32:35], s59 offen offset:3072 lds
    s_add_u32 s59, s59, s60
    s_cmp_eq_u32 s59, s34
    s_cselect_b32 s59, 0, s59
    s_waitcnt vmcnt(12)
    s_barrier
    s_add_u32 m0, s61, 32768
    s_nop 0
    buffer_load_dwordx4 v40, s[32:35], s59 offen offset:0 lds
    buffer_load_dwordx4 v41, s[32:35], s59 offen offset:1024 lds
    buffer_load_dwordx4 v42, s[32:35], s59 offen offset:2048 lds
    buffer_load_dwordx4 v43, s[32:35], s59 offen offset:3072 lds
    s_add_u32 s59, s59, s60
    s_cmp_eq_u32 s59, s34
    s_cselect_b32 s59, 0, s59
    s_add_u32 m0, s62, 16384
    s_nop 0
    buffer_load_dwordx4 v44, s[28:31], s58 offen offset:0 lds
    buffer_load_dwordx4 v45, s[28:31], s58 offen offset:1024 lds
    buffer_load_dwordx4 v46, s[28:31], s58 offen offset:2048 lds
    buffer_load_dwordx4 v47, s[28:31], s58 offen offset:3072 lds
    s_add_u32 s58, s58, 128
    s_cmp_eq_u32 s58, 1280
    s_cselect_b32 s58, 0, s58
    s_add_u32 m0, s61, 49152
    s_nop 0
    buffer_load_dwordx4 v40, s[32:35], s59 offen offset:0 lds
    buffer_load_dwordx4 v41, s[32:35], s59 offen offset:1024 lds
    buffer_load_dwordx4 v42, s[32:35], s59 offen offset:2048 lds
    buffer_load_dwordx4 v43, s[32:35], s59 offen offset:3072 lds
    s_add_u32 s59, s59, s60
    s_cmp_eq_u32 s59, s34
    s_cselect_b32 s59, 0, s59
    s_cmp_lg_u32 s71, 0
    s_cbranch_scc1 k1lf_82
    buffer_load_dword v153, v152, s[36:39], 0 offen sc0 sc1
k1lf_82:
    s_cmp_lg_u32 s71, 1
    s_cbranch_scc1 k1lf_83
    buffer_load_dword v153, v152, s[36:39], 0 offen sc0 sc1
k1lf_83:
    s_waitcnt vmcnt(12)
    s_barrier
    s_add_u32 m0, s61, 65536
    s_nop 0
    buffer_load_dwordx4 v40, s[32:35], s59 offen offset:0 lds
    buffer_load_dwordx4 v41, s[32:35], s59 offen offset:1024 lds
    buffer_load_dwordx4 v42, s[32:35], s59 offen offset:2048 lds
    buffer_load_dwordx4 v43, s[32:35], s59 offen offset:3072 lds
    s_add_u32 s59, s59, s60
    s_cmp_eq_u32 s59, s34
    s_cselect_b32 s59, 0, s59
    s_add_u32 m0, s62, 32768
    s_nop 0
    buffer_load_dwordx4 v44, s[28:31], s58 offen offset:0 lds
    buffer_load_dwordx4 v45, s[28:31], s58 offen offset:1024 lds
    buffer_load_dwordx4 v46, s[28:31], s58 offen offset:2048 lds
    buffer_load_dwordx4 v47, s[28:31], s58 offen offset:3072 lds
    s_add_u32 s58, s58, 128
    s_cmp_eq_u32 s58, 1280
    s_cselect_b32 s58, 0, s58
    s_add_u32 m0, s61, 81920
    s_nop 0
    buffer_load_dwordx4 v40, s[32:35], s59 offen offset:0 lds
    buffer_load_dwordx4 v41, s[32:35], s59 offen offset:1024 lds
    buffer_load_dwordx4 v42, s[32:35], s59 offen offset:2048 lds
    buffer_load_dwordx4 v43, s[32:35], s59 offen offset:3072 lds
    s_add_u32 s59, s59, s60
    s_cmp_eq_u32 s59, s34
    s_cselect_b32 s59, 0, s59
    s_cmp_lg_u32 s71, 2
    s_cbranch_scc1 k1lf_84
    buffer_load_dword v153, v152, s[36:39], 0 offen sc0 sc1
k1lf_84:
    s_cmp_lg_u32 s71, 3
    s_cbranch_scc1 k1lf_85
    buffer_load_dword v153, v152, s[36:39], 0 offen sc0 sc1
k1lf_85:
    s_waitcnt vmcnt(12)
    s_barrier
    s_add_u32 m0, s61, 0
    s_nop 0
    buffer_load_dwordx4 v40, s[32:35], s59 offen offset:0 lds
    buffer_load_dwordx4 v41, s[32:35], s59 offen offset:1024 lds
    buffer_load_dwordx4 v42, s[32:35], s59 offen offset:2048 lds
    buffer_load_dwordx4 v43, s[32:35], s59 offen offset:3072 lds
    s_add_u32 s59, s59, s60
    s_cmp_eq_u32 s59, s34
    s_cselect_b32 s59, 0, s59
    s_add_u32 m0, s62, 0
    s_nop 0
    buffer_load_dwordx4 v44, s[28:31], s58 offen offset:0 lds
    buffer_load_dwordx4 v45, s[28:31], s58 offen offset:1024 lds
    buffer_load_dwordx4 v46, s[28:31], s58 offen offset:2048 lds
    buffer_load_dwordx4 v47, s[28:31], s58 offen offset:3072 lds
    s_add_u32 s58, s58, 128
    s_cmp_eq_u32 s58, 1280
    s_cselect_b32 s58, 0, s58
    s_add_u32 m0, s61, 16384
    s_nop 0
    buffer_load_dwordx4 v40, s[32:35], s59 offen offset:0 lds
    buffer_load_dwordx4 v41, s[32:35], s59 offen offset:1024 lds
    buffer_load_dwordx4 v42, s[32:35], s59 offen offset:2048 lds
    buffer_load_dwordx4 v43, s[32:35], s59 offen offset:3072 lds
    s_add_u32 s59, s59, s60
    s_cmp_eq_u32 s59, s34
    s_cselect_b32 s59, 0, s59
    s_cmp_lg_u32 s45, 0
    s_cbranch_scc1 k1p_75
    s_waitcnt vmcnt(12)
k1p_74:
    v_cmp_ne_u32 vcc, 1, v153
    s_add_u32 s63, s63, 1
    s_cmp_ge_u32 s63, 0x40000
    s_cbranch_vccz k1p_75
    s_cbranch_scc1 k1p_75
    s_sleep 32
    buffer_load_dword v153, v152, s[36:39], 0 offen sc0 sc1
    s_waitcnt vmcnt(0)
    s_branch k1p_74
k1p_75:
    s_waitcnt vmcnt(12)
    s_barrier
    s_add_u32 m0, s61, 32768
    s_nop 0
    buffer_load_dwordx4 v40, s[32:35], s59 offen offset:0 lds
    buffer_load_dwordx4 v41, s[32:35], s59 offen offset:1024 lds
    buffer_load_dwordx4 v42, s[32:35], s59 offen offset:2048 lds
    buffer_load_dwordx4 v43, s[32:35], s59 offen offset:3072 lds
    s_add_u32 s59, s59, s60
    s_cmp_eq_u32 s59, s34
    s_cselect_b32 s59, 0, s59
    s_add_u32 m0, s62, 16384
    s_nop 0
    buffer_load_dwordx4 v44, s[28:31], s58 offen offset:0 lds
    buffer_load_dwordx4 v45, s[28:31], s58 offen offset:1024 lds
    buffer_load_dwordx4 v46, s[28:31], s58 offen offset:2048 lds
    buffer_load_dwordx4 v47, s[28:31], s58 offen offset:3072 lds
    s_add_u32 s58, s58, 128
    s_cmp_eq_u32 s58, 1280
    s_cselect_b32 s58, 0, s58
    s_add_u32 m0, s61, 49152
    s_nop 0
    buffer_load_dwordx4 v40, s[32:35], s59 offen offset:0 lds
    buffer_load_dwordx4 v41, s[32:35], s59 offen offset:1024 lds
    buffer_load_dwordx4 v42, s[32:35], s59 offen offset:2048 lds
    buffer_load_dwordx4 v43, s[32:35], s59 offen offset:3072 lds
    s_add_u32 s59, s59, s60
    s_cmp_eq_u32 s59, s34
    s_cselect_b32 s59, 0, s59
    s_waitcnt vmcnt(12)
    s_barrier
    s_add_u32 m0, s61, 65536
    s_nop 0
    buffer_load_dwordx4 v40, s[32:35], s59 offen offset:0 lds
    buffer_load_dwordx4 v41, s[32:35], s59 offen offset:1024 lds
    buffer_load_dwordx4 v42, s[32:35], s59 offen offset:2048 lds
    buffer_load_dwordx4 v43, s[32:35], s59 offen offset:3072 lds
    s_add_u32 s59, s59, s60
    s_cmp_eq_u32 s59, s34
    s_cselect_b32 s59, 0, s59
    s_add_u32 m0, s62, 32768
    s_nop 0
    buffer_load_dwordx4 v44, s[28:31], s58 offen offset:0 lds
    buffer_load_dwordx4 v45, s[28:31], s58 offen offset:1024 lds
    buffer_load_dwordx4 v46, s[28:31], s58 offen offset:2048 lds
    buffer_load_dwordx4 v47, s[28:31], s58 offen offset:3072 lds
    s_add_u32 s58, s58, 128
    s_cmp_eq_u32 s58, 1280
    s_cselect_b32 s58, 0, s58
    s_add_u32 m0, s61, 81920
    s_nop 0
    buffer_load_dwordx4 v40, s[32:35], s59 offen offset:0 lds
    buffer_load_dwordx4 v41, s[32:35], s59 offen offset:1024 lds
    buffer_load_dwordx4 v42, s[32:35], s59 offen offset:2048 lds
    buffer_load_dwordx4 v43, s[32:35], s59 offen offset:3072 lds
    s_add_u32 s59, s59, s60
    s_cmp_eq_u32 s59, s34
    s_cselect_b32 s59, 0, s59
    s_waitcnt vmcnt(12)
    s_barrier
    s_add_u32 m0, s61, 0
    s_nop 0
    buffer_load_dwordx4 v40, s[32:35], s59 offen offset:0 lds
    buffer_load_dwordx4 v41, s[32:35], s59 offen offset:1024 lds
    buffer_load_dwordx4 v42, s[32:35], s59 offen offset:2048 lds
    buffer_load_dwordx4 v43, s[32:35], s59 offen offset:3072 lds
    s_add_u32 s59, s59, s60
    s_cmp_eq_u32 s59, s34
    s_cselect_b32 s59, 0, s59
    s_add_u32 m0, s62, 0
    s_nop 0
    buffer_load_dwordx4 v44, s[28:31], s58 offen offset:0 lds
    buffer_load_dwordx4 v45, s[28:31], s58 offen offset:1024 lds
    buffer_load_dwordx4 v46, s[28:31], s58 offen offset:2048 lds
    buffer_load_dwordx4 v47, s[28:31], s58 offen offset:3072 lds
    s_add_u32 s58, s58, 128
    s_cmp_eq_u32 s58, 1280
    s_cselect_b32 s58, 0, s58
    s_add_u32 m0, s61, 16384
    s_nop 0
    buffer_load_dwordx4 v40, s[32:35], s59 offen offset:0 lds
    buffer_load_dwordx4 v41, s[32:35], s59 offen offset:1024 lds
    buffer_load_dwordx4 v42, s[32:35], s59 offen offset:2048 lds
    buffer_load_dwordx4 v43, s[32:35], s59 offen offset:3072 lds
    s_add_u32 s59, s59, s60
    s_cmp_eq_u32 s59, s34
    s_cselect_b32 s59, 0, s59
    s_waitcnt vmcnt(12)
    s_barrier
    s_mul_i32 s49, s48, 27648
    s_lshl_b32 s50, s45, 8
    s_add_u32 s49, s49, s50
    s_add_u32 s49, s49, 10240
    s_mul_i32 s50, s47, 27648
    buffer_load_dword v108, v154, s[80:83], s49 offen offset:0 sc0 sc1
    buffer_load_dwordx2 v[120:121], v105, s[80:83], s50 offen offset:0 sc0 sc1
    buffer_load_dword v109, v154, s[80:83], s49 offen offset:1024 sc0 sc1
    buffer_load_dwordx2 v[122:123], v105, s[80:83], s50 offen offset:1024 sc0 sc1
    buffer_load_dword v110, v154, s[80:83], s49 offen offset:2048 sc0 sc1
    buffer_load_dwordx2 v[124:125], v105, s[80:83], s50 offen offset:2048 sc0 sc1
    buffer_load_dword v111, v154, s[80:83], s49 offen offset:3072 sc0 sc1
    buffer_load_dwordx2 v[126:127], v105, s[80:83], s50 offen offset:3072 sc0 sc1
    s_add_u32 s49, s49, 4096
    s_add_u32 s50, s50, 4096
    buffer_load_dword v112, v154, s[80:83], s49 offen offset:0 sc0 sc1
    buffer_load_dwordx2 v[128:129], v105, s[80:83], s50 offen offset:0 sc0 sc1
    buffer_load_dword v113, v154, s[80:83], s49 offen offset:1024 sc0 sc1
    buffer_load_dwordx2 v[130:131], v105, s[80:83], s50 offen offset:1024 sc0 sc1
    buffer_load_dword v114, v154, s[80:83], s49 offen offset:2048 sc0 sc1
    buffer_load_dwordx2 v[132:133], v105, s[80:83], s50 offen offset:2048 sc0 sc1
    buffer_load_dword v115, v154, s[80:83], s49 offen offset:3072 sc0 sc1
    buffer_load_dwordx2 v[134:135], v105, s[80:83], s50 offen offset:3072 sc0 sc1
    s_add_u32 s49, s49, 4096
    s_add_u32 s50, s50, 4096
    buffer_load_dword v116, v154, s[80:83], s49 offen offset:0 sc0 sc1
    buffer_load_dwordx2 v[136:137], v105, s[80:83], s50 offen offset:0 sc0 sc1
    buffer_load_dword v117, v154, s[80:83], s49 offen offset:1024 sc0 sc1
    buffer_load_dwordx2 v[138:139], v105, s[80:83], s50 offen offset:1024 sc0 sc1
    s_waitcnt vmcnt(20)
    s_barrier
    s_barrier
k1ld_86:
    s_waitcnt vmcnt(0)
    v_max_u32 v153, v108, v109
    v_max3_u32 v153, v153, v110, v111
    v_max3_u32 v153, v153, v112, v113
    v_max3_u32 v153, v153, v114, v115
    v_max3_u32 v153, v153, v116, v117
    v_max3_u32 v153, v153, v120, v121
    v_max3_u32 v153, v153, v122, v123
    v_max3_u32 v153, v153, v124, v125
    v_max3_u32 v153, v153, v126, v127
    v_max3_u32 v153, v153, v128, v129
    v_max3_u32 v153, v153, v130, v131
    v_max3_u32 v153, v153, v132, v133
    v_max3_u32 v153, v153, v134, v135
    v_max3_u32 v153, v153, v136, v137
    v_max3_u32 v153, v153, v138, v139
    v_cmp_eq_u32 vcc, -1, v153
    s_add_u32 s63, s63, 1
    s_cmp_ge_u32 s63, 0x40000
    s_cbranch_vccz k1ld_87
    s_cbranch_scc1 k1ld_87
    s_sleep 4
    s_mul_i32 s49, s48, 27648
    s_lshl_b32 s50, s45, 8
    s_add_u32 s49, s49, s50
    s_add_u32 s49, s49, 10240
    s_mul_i32 s50, s47, 27648
    buffer_load_dword v108, v154, s[80:83], s49 offen offset:0 sc0 sc1
    buffer_load_dwordx2 v[120:121], v105, s[80:83], s50 offen offset:0 sc0 sc1
    buffer_load_dword v109, v154, s[80:83], s49 offen offset:1024 sc0 sc1
    buffer_load_dwordx2 v[122:123], v105, s[80:83], s50 offen offset:1024 sc0 sc1
    buffer_load_dword v110, v154, s[80:83], s49 offen offset:2048 sc0 sc1
    buffer_load_dwordx2 v[124:125], v105, s[80:83], s50 offen offset:2048 sc0 sc1
    buffer_load_dword v111, v154, s[80:83], s49 offen offset:3072 sc0 sc1
    buffer_load_dwordx2 v[126:127], v105, s[80:83], s50 offen offset:3072 sc0 sc1
    s_add_u32 s49, s49, 4096
    s_add_u32 s50, s50, 4096
    buffer_load_dword v112, v154, s[80:83], s49 offen offset:0 sc0 sc1
    buffer_load_dwordx2 v[128:129], v105, s[80:83], s50 offen offset:0 sc0 sc1
    buffer_load_dword v113, v154, s[80:83], s49 offen offset:1024 sc0 sc1
    buffer_load_dwordx2 v[130:131], v105, s[80:83], s50 offen offset:1024 sc0 sc1
    buffer_load_dword v114, v154, s[80:83], s49 offen offset:2048 sc0 sc1
    buffer_load_dwordx2 v[132:133], v105, s[80:83], s50 offen offset:2048 sc0 sc1
    buffer_load_dword v115, v154, s[80:83], s49 offen offset:3072 sc0 sc1
    buffer_load_dwordx2 v[134:135], v105, s[80:83], s50 offen offset:3072 sc0 sc1
    s_add_u32 s49, s49, 4096
    s_add_u32 s50, s50, 4096
    buffer_load_dword v116, v154, s[80:83], s49 offen offset:0 sc0 sc1
    buffer_load_dwordx2 v[136:137], v105, s[80:83], s50 offen offset:0 sc0 sc1
    buffer_load_dword v117, v154, s[80:83], s49 offen offset:1024 sc0 sc1
    buffer_load_dwordx2 v[138:139], v105, s[80:83], s50 offen offset:1024 sc0 sc1
    s_branch k1ld_86
k1ld_87:
    v_pk_add_f32 v[108:109], v[108:109], v[110:111]
    v_pk_add_f32 v[108:109], v[108:109], v[112:113]
    v_pk_add_f32 v[108:109], v[108:109], v[114:115]
    v_pk_add_f32 v[108:109], v[108:109], v[116:117]
    v_pk_add_f32 v[120:121], v[120:121], v[130:131]
    v_pk_add_f32 v[122:123], v[122:123], v[132:133]
    v_pk_add_f32 v[124:125], v[124:125], v[134:135]
    v_pk_add_f32 v[126:127], v[126:127], v[136:137]
    v_pk_add_f32 v[128:129], v[128:129], v[138:139]
    v_pk_add_f32 v[120:121], v[120:121], v[122:123]
    v_pk_add_f32 v[120:121], v[120:121], v[124:125]
    v_pk_add_f32 v[120:121], v[120:121], v[126:127]
    v_pk_add_f32 v[120:121], v[120:121], v[128:129]
    v_mul_f32 v120, 0x3acccccd, v120
    v_mul_f32 v121, 0x3acccccd, v121
    v_fma_f32 v121, -v120, v120, v121
    v_max_f32 v121, 0, v121
    v_cvt_pk_bf16_f32 v120, v120, v120
    v_and_b32 v120, 0xffff0000, v120
    v_cvt_pk_bf16_f32 v121, v121, v121
    v_and_b32 v121, 0xffff0000, v121
    v_add_f32 v121, 0x3727c5ac, v121
    v_cvt_pk_bf16_f32 v121, v121, v121
    v_and_b32 v121, 0xffff0000, v121
    v_sqrt_f32 v121, v121
    s_nop 0
    v_cvt_pk_bf16_f32 v121, v121, v121
    v_and_b32 v121, 0xffff0000, v121
    v_rcp_f32 v121, v121
    v_add_f32 v108, v108, v109
    s_lshl_b32 s49, s45, 8
    s_add_u32 s49, s49, 147712
    v_add_u32 v11, s49, v154
    v_add_u32 v12, 147712, v104
    ds_write_b32 v11, v108 offset:1024
    ds_write_b32 v12, v121 offset:0
    ds_write_b32 v12, v120 offset:512
    s_waitcnt lgkmcnt(0)
    s_barrier
    s_mov_b32 s28, s14
    s_mov_b32 s29, s15
    s_mov_b32 s30, 0x800000
    s_mov_b32 s31, 0x20000
    s_and_b32 s49, s2, 0x19
    s_cmp_eq_u32 s49, 1
    s_cbranch_scc1 k1x_91
    s_and_b32 s49, s2, 6
    s_and_b32 s51, s2, 1
    s_lshl_b32 s51, s51, 2
    s_add_u32 s51, s51, s49
    s_lshl_b32 s59, s51, 9
    s_and_b32 s59, s59, 0xfff
    s_lshl_b32 s49, s49, 2
    s_lshr_b32 s50, s2, 5
    s_add_u32 s49, s49, s50
    s_lshl_b32 s49, s49, 6
    s_lshl_b32 s50, s45, 4
    s_add_u32 s49, s49, s50
    v_and_b32 v48, 15, v0
    v_bfe_u32 v49, v0, 4, 2
    v_xor_b32 v48, v48, v49
    s_and_b32 s50, s45, 1
    s_lshl_b32 s50, s50, 3
    v_xor_b32 v48, s50, v48
    v_add_u32 v49, s49, v49
    v_lshlrev_b32 v49, 12, v49
    v_lshl_add_u32 v44, v48, 4, v49
    v_add_u32 v45, 15360, v44
    v_xor_b32 v48, 4, v48
    v_lshl_add_u32 v46, v48, 4, v49
    v_add_u32 v47, 46080, v46
    v_add_u32 v46, 30720, v46
    s_add_u32 m0, s62, 65536
    s_nop 0
    buffer_load_dwordx4 v44, s[28:31], s59 offen offset:0 lds
    buffer_load_dwordx4 v45, s[28:31], s59 offen offset:1024 lds
    buffer_load_dwordx4 v46, s[28:31], s59 offen offset:2048 lds
    buffer_load_dwordx4 v47, s[28:31], s59 offen offset:3072 lds
    s_add_u32 s59, s59, 256
    s_and_b32 s59, s59, 0xfff
    s_add_u32 m0, s62, 81920
    s_nop 0
    buffer_load_dwordx4 v44, s[28:31], s59 offen offset:0 lds
    buffer_load_dwordx4 v45, s[28:31], s59 offen offset:1024 lds
    buffer_load_dwordx4 v46, s[28:31], s59 offen offset:2048 lds
    buffer_load_dwordx4 v47, s[28:31], s59 offen offset:3072 lds
    s_add_u32 s59, s59, 256
    s_and_b32 s59, s59, 0xfff
    s_add_u32 m0, s62, 98304
    s_nop 0
    buffer_load_dwordx4 v44, s[28:31], s59 offen offset:0 lds
    buffer_load_dwordx4 v45, s[28:31], s59 offen offset:1024 lds
    buffer_load_dwordx4 v46, s[28:31], s59 offen offset:2048 lds
    buffer_load_dwordx4 v47, s[28:31], s59 offen offset:3072 lds
    s_add_u32 s59, s59, 256
    s_and_b32 s59, s59, 0xfff
    s_add_u32 m0, s62, 114688
    s_nop 0
    buffer_load_dwordx4 v44, s[28:31], s59 offen offset:0 lds
    buffer_load_dwordx4 v45, s[28:31], s59 offen offset:1024 lds
    buffer_load_dwordx4 v46, s[28:31], s59 offen offset:2048 lds
    buffer_load_dwordx4 v47, s[28:31], s59 offen offset:3072 lds
    s_add_u32 s59, s59, 256
    s_and_b32 s59, s59, 0xfff
    s_add_u32 m0, s62, 131072
    s_nop 0
    buffer_load_dwordx4 v44, s[28:31], s59 offen offset:0 lds
    buffer_load_dwordx4 v45, s[28:31], s59 offen offset:1024 lds
    buffer_load_dwordx4 v46, s[28:31], s59 offen offset:2048 lds
    buffer_load_dwordx4 v47, s[28:31], s59 offen offset:3072 lds
    s_add_u32 s59, s59, 256
    s_and_b32 s59, s59, 0xfff
k1x_91:
    s_cmp_lt_u32 s48, 8
    s_cbranch_scc1 k1x_89
    s_sub_u32 s50, s48, 8
    s_cmp_ge_u32 s50, 7
    s_cbranch_scc1 k1x_88
    s_cmp_ge_u32 s45, 2
    s_cbranch_scc1 k1x_90
    s_mul_i32 s72, s47, 27648
    s_add_u32 s72, s72, 20480
    s_lshl_b32 s73, s50, 10
    s_add_u32 s73, s73, s72
    s_add_u32 s51, s72, 4096
    s_add_u32 s40, s24, 0xb50000
    s_addc_u32 s41, s25, 0
    s_mov_b32 s42, 0x6c000
    s_mov_b32 s43, 0x20000
    s_barrier
    ds_read2st64_b32 v[108:109], v104 offset0:0 offset1:2
    ds_read2st64_b32 v[110:111], v104 offset0:4 offset1:6
    ds_read2st64_b32 v[112:113], v104 offset0:8 offset1:10
    ds_read2st64_b32 v[114:115], v104 offset0:12 offset1:14
    s_waitcnt lgkmcnt(0)
    v_pk_add_f32 v[108:109], v[108:109], v[110:111]
    v_pk_add_f32 v[112:113], v[112:113], v[114:115]
    v_pk_add_f32 v[108:109], v[108:109], v[112:113]
    v_min_u32 v108, -2, v108
    v_min_u32 v109, -2, v109
    buffer_store_dwordx2 v[108:109], v105, s[40:43], s73 offen sc0 sc1
    s_sleep 8
    buffer_load_dwordx2 v[112:113], v105, s[40:43], s72 offen offset:0 sc0 sc1
    buffer_load_dwordx2 v[114:115], v105, s[40:43], s72 offen offset:1024 sc0 sc1
    buffer_load_dwordx2 v[116:117], v105, s[40:43], s72 offen offset:2048 sc0 sc1
    buffer_load_dwordx2 v[118:119], v105, s[40:43], s72 offen offset:3072 sc0 sc1
    buffer_load_dwordx2 v[120:121], v105, s[40:43], s51 offen offset:0 sc0 sc1
    buffer_load_dwordx2 v[122:123], v105, s[40:43], s51 offen offset:1024 sc0 sc1
    buffer_load_dwordx2 v[124:125], v105, s[40:43], s51 offen offset:2048 sc0 sc1
k1p_76:
    s_sleep 5
    buffer_load_dwordx2 v[128:129], v105, s[40:43], s72 offen offset:0 sc0 sc1
    buffer_load_dwordx2 v[130:131], v105, s[40:43], s72 offen offset:1024 sc0 sc1
    buffer_load_dwordx2 v[132:133], v105, s[40:43], s72 offen offset:2048 sc0 sc1
    buffer_load_dwordx2 v[134:135], v105, s[40:43], s72 offen offset:3072 sc0 sc1
    buffer_load_dwordx2 v[136:137], v105, s[40:43], s51 offen offset:0 sc0 sc1
    buffer_load_dwordx2 v[138:139], v105, s[40:43], s51 offen offset:1024 sc0 sc1
    buffer_load_dwordx2 v[140:141], v105, s[40:43], s51 offen offset:2048 sc0 sc1
    s_add_u32 s63, s63, 1
    s_waitcnt vmcnt(7)
    v_max_u32 v106, v112, v113
    v_max3_u32 v106, v106, v114, v115
    v_max3_u32 v106, v106, v116, v117
    v_max3_u32 v106, v106, v118, v119
    v_max3_u32 v106, v106, v120, v121
    v_max3_u32 v106, v106, v122, v123
    v_max3_u32 v106, v106, v124, v125
    v_cmp_eq_u32 vcc, -1, v106
    s_nop 1
    s_cbranch_vccz k1p_77
    s_cmp_ge_u32 s63, 0x40000
    s_cbranch_scc1 k1p_77
    s_sleep 5
    buffer_load_dwordx2 v[112:113], v105, s[40:43], s72 offen offset:0 sc0 sc1
    buffer_load_dwordx2 v[114:115], v105, s[40:43], s72 offen offset:1024 sc0 sc1
    buffer_load_dwordx2 v[116:117], v105, s[40:43], s72 offen offset:2048 sc0 sc1
    buffer_load_dwordx2 v[118:119], v105, s[40:43], s72 offen offset:3072 sc0 sc1
    buffer_load_dwordx2 v[120:121], v105, s[40:43], s51 offen offset:0 sc0 sc1
    buffer_load_dwordx2 v[122:123], v105, s[40:43], s51 offen offset:1024 sc0 sc1
    buffer_load_dwordx2 v[124:125], v105, s[40:43], s51 offen offset:2048 sc0 sc1
    s_waitcnt vmcnt(7)
    v_max_u32 v106, v128, v129
    v_max3_u32 v106, v106, v130, v131
    v_max3_u32 v106, v106, v132, v133
    v_max3_u32 v106, v106, v134, v135
    v_max3_u32 v106, v106, v136, v137
    v_max3_u32 v106, v106, v138, v139
    v_max3_u32 v106, v106, v140, v141
    v_cmp_eq_u32 vcc, -1, v106
    s_nop 1
    s_cbranch_vccnz k1p_76
    v_pk_add_f32 v[128:129], v[128:129], v[130:131]
    v_pk_add_f32 v[128:129], v[128:129], v[132:133]
    v_pk_add_f32 v[128:129], v[128:129], v[134:135]
    v_pk_add_f32 v[128:129], v[128:129], v[136:137]
    v_pk_add_f32 v[128:129], v[128:129], v[138:139]
    v_pk_add_f32 v[128:129], v[128:129], v[140:141]
    v_mov_b32 v144, v128
    v_mov_b32 v145, v129
    s_branch k1p_92
k1p_77:
    v_pk_add_f32 v[112:113], v[112:113], v[114:115]
    v_pk_add_f32 v[112:113], v[112:113], v[116:117]
    v_pk_add_f32 v[112:113], v[112:113], v[118:119]
    v_pk_add_f32 v[112:113], v[112:113], v[120:121]
    v_pk_add_f32 v[112:113], v[112:113], v[122:123]
    v_pk_add_f32 v[112:113], v[112:113], v[124:125]
    v_mov_b32 v144, v112
    v_mov_b32 v145, v113
k1p_92:
    v_mul_f32 v144, 0x3a97b426, v144
    v_mul_f32 v145, 0x3a97b426, v145
    v_fma_f32 v145, -v144, v144, v145
    v_max_f32 v145, 0, v145
    v_cvt_pk_bf16_f32 v144, v144, v144
    v_and_b32 v144, 0xffff0000, v144
    v_cvt_pk_bf16_f32 v145, v145, v145
    v_and_b32 v145, 0xffff0000, v145
    v_add_f32 v145, 0x3727c5ac, v145
    v_cvt_pk_bf16_f32 v145, v145, v145
    v_and_b32 v145, 0xffff0000, v145
    v_sqrt_f32 v145, v145
    s_nop 0
    v_cvt_pk_bf16_f32 v145, v145, v145
    v_and_b32 v145, 0xffff0000, v145
    v_rcp_f32 v145, v145
    s_nop 0
    v_mul_f32 v144, v144, v145
    ds_write_b32 v12, v145 offset:2048
    ds_write_b32 v12, v144 offset:2560
    s_waitcnt lgkmcnt(0)
    s_branch k1x_89
k1x_90:
    s_barrier
k1x_89:
    s_barrier
k1x_88:
    s_waitcnt vmcnt(0)
    s_barrier
    s_branch parallel_sum__linear_attn_block__mixer_gmlp__prompt_kernel_p2
k1comp_2:
    v_mov_b32 v152, v6
    v_lshlrev_b32 v156, 4, v152
    v_and_b32 v153, 15, v0
    v_bfe_u32 v154, v0, 4, 2
    v_lshrrev_b32 v157, 2, v153
    v_and_b32 v158, 3, v153
    v_lshl_add_u32 v157, v157, 3, v158
    s_lshl_b32 s49, s46, 6
    v_add_u32 v155, s49, v157
    s_mov_b32 s64, 0x3f803f80
    v_lshlrev_b32 v157, 7, v155
    v_lshrrev_b32 v158, 1, v153
    v_xor_b32 v158, v158, v154
    v_lshl_add_u32 v1, v158, 4, v157
    v_bfe_u32 v157, v152, 2, 2
    v_lshlrev_b32 v158, 10, v154
    v_lshl_add_u32 v158, v157, 7, v158
    v_and_b32 v159, 3, v152
    v_lshl_add_u32 v158, v159, 3, v158
    v_add_u32 v158, 49152, v158
    v_bfe_u32 v159, v152, 3, 2
    v_xor_b32 v159, s45, v159
    v_lshl_add_u32 v2, v159, 5, v158
    s_mov_b32 s57, 0x4000
    v_mov_b32 v16, v1
    v_mov_b32 v17, v2
    s_mov_b32 s58, 0
    s_mov_b32 s63, 0
    s_add_u32 s49, s47, s48
    s_mul_i32 s50, s49, 128
    s_lshr_b32 s50, s50, 8
    s_mul_i32 s50, s50, 2
    s_sub_u32 s49, s49, s50
    s_mul_i32 s49, s49, 5
    s_mul_i32 s60, s48, 128
    s_lshr_b32 s60, s60, 8
    s_mul_i32 s62, s47, 27
    s_add_u32 s62, s62, s49
    s_add_u32 s62, s62, s60
    s_lshl_b32 s62, s62, 10
    s_cmp_ge_u32 s60, 5
    s_cselect_b32 s60, 31, s60
    s_cselect_b32 s62, 442368, s62
    s_mul_i32 s59, s47, 128
    s_lshr_b32 s59, s59, 8
    s_mul_i32 s61, s48, 27
    s_add_u32 s61, s61, s49
    s_add_u32 s61, s61, s59
    s_add_u32 s61, s61, 10
    s_lshl_b32 s61, s61, 10
    s_cmp_ge_u32 s59, 5
    s_cselect_b32 s59, 31, s59
    s_cselect_b32 s61, 442368, s61
    s_cmp_eq_u32 s46, 1
    s_cselect_b32 s59, 31, s59
    s_cselect_b32 s61, 442368, s61
    s_waitcnt lgkmcnt(0)
    v_mov_b32 v164, -1
    v_mov_b32 v40, 0
    v_mov_b32 v165, -1
    v_mov_b32 v41, 0
    v_mov_b32 v166, -1
    v_mov_b32 v42, 0
    v_mov_b32 v167, -1
    v_mov_b32 v43, 0
    s_add_u32 s36, s24, 0xb40000
    s_addc_u32 s37, s25, 0
    s_mov_b32 s38, 0x3800
    s_mov_b32 s39, 0x20000
    s_add_u32 s80, s24, 0xb50000
    s_addc_u32 s81, s25, 0
    s_mov_b32 s82, 0x6c000
    s_mov_b32 s83, 0x20000
    s_cmp_lg_u32 s48, 15
    s_cbranch_scc1 k1inv_8
    s_mul_i32 s49, s47, 27648
    s_add_u32 s82, s49, 27648
    s_lshl_b32 s50, s44, 12
    s_add_u32 s49, s49, s50
    s_min_u32 s49, s49, s82
    buffer_store_dwordx4 v[164:167], v156, s[80:83], s49 offen sc0 sc1
    buffer_store_dwordx4 v[164:167], v156, s[80:83], s49 offen offset:1024 sc0 sc1
    buffer_store_dwordx4 v[164:167], v156, s[80:83], s49 offen offset:2048 sc0 sc1
    buffer_store_dwordx4 v[164:167], v156, s[80:83], s49 offen offset:3072 sc0 sc1
    s_mov_b32 s82, 442368
k1inv_8:
    s_lshl_b32 s49, s47, 4
    s_add_u32 s49, s49, s48
    s_cmp_lg_u32 s49, 15
    s_cbranch_scc1 k1zc_10
    v_lshlrev_b32 v157, 4, v0
    s_movk_i32 s49, 0x2000
    buffer_store_dwordx4 v[40:43], v157, s[36:39], 0 offen sc0 sc1
    buffer_store_dwordx4 v[40:43], v157, s[36:39], s49 offen sc0 sc1
k1zc_10:
    s_mov_b32 m0, 147456
    v_mov_b32 v44, 0
    v_mov_b32 v45, 0
    v_mov_b32 v46, 0
    v_mov_b32 v47, 0
    v_mov_b32 v48, 0
    v_mov_b32 v49, 0
    v_mov_b32 v50, 0
    v_mov_b32 v51, 0
    v_mov_b32 v52, 0
    v_mov_b32 v53, 0
    v_mov_b32 v54, 0
    v_mov_b32 v55, 0
    v_mov_b32 v56, 0
    v_mov_b32 v57, 0
    v_mov_b32 v58, 0
    v_mov_b32 v59, 0
    v_mov_b32 v60, 0
    v_mov_b32 v61, 0
    v_mov_b32 v62, 0
    v_mov_b32 v63, 0
    v_mov_b32 v64, 0
    v_mov_b32 v65, 0
    v_mov_b32 v66, 0
    v_mov_b32 v67, 0
    v_mov_b32 v68, 0
    v_mov_b32 v69, 0
    v_mov_b32 v70, 0
    v_mov_b32 v71, 0
    v_mov_b32 v72, 0
    v_mov_b32 v73, 0
    v_mov_b32 v74, 0
    v_mov_b32 v75, 0
    v_mov_b32 v76, 0
    v_mov_b32 v77, 0
    v_mov_b32 v78, 0
    v_mov_b32 v79, 0
    v_mov_b32 v80, 0
    v_mov_b32 v81, 0
    v_mov_b32 v82, 0
    v_mov_b32 v83, 0
    v_mov_b32 v84, 0
    v_mov_b32 v85, 0
    v_mov_b32 v86, 0
    v_mov_b32 v87, 0
    v_mov_b32 v88, 0
    v_mov_b32 v89, 0
    v_mov_b32 v90, 0
    v_mov_b32 v91, 0
    v_mov_b32 v92, 0
    v_mov_b32 v93, 0
    v_mov_b32 v94, 0
    v_mov_b32 v95, 0
    v_mov_b32 v96, 0
    v_mov_b32 v97, 0
    v_mov_b32 v98, 0
    v_mov_b32 v99, 0
    v_mov_b32 v100, 0
    v_mov_b32 v101, 0
    v_mov_b32 v102, 0
    v_mov_b32 v103, 0
    v_mov_b32 v20, s64
    v_mov_b32 v21, s64
    v_mov_b32 v22, s64
    v_mov_b32 v23, s64
    s_mov_b32 s28, s14
    s_mov_b32 s29, s15
    s_mov_b32 s30, 0x800000
    s_mov_b32 s31, 0x20000
    s_bfe_u32 s50, s2, 0x20001
    s_lshl_b32 s50, s50, 7
    s_lshr_b32 s51, s2, 3
    s_lshl_b32 s51, s51, 2
    s_add_u32 s50, s50, s51
    s_add_u32 s50, s50, s44
    s_lshl_b32 s70, s50, 14
    s_mul_i32 s71, s44, 0
    s_lshr_b32 s71, s71, 1
    s_add_u32 s71, s71, 6
    s_and_b32 s50, s2, 6
    s_and_b32 s51, s2, 1
    s_lshl_b32 s51, s51, 2
    s_add_u32 s50, s50, s51
    s_lshl_b32 s50, s50, 9
    v_lshl_add_u32 v157, v153, 7, s50
    v_and_b32 v157, 0xfff, v157
    v_lshl_add_u32 v3, v154, 12, v157
    s_cmp_lt_u32 s44, 4
    s_cbranch_scc1 k1pf_11
    s_mov_b32 s71, 6
    v_lshlrev_b32 v3, 7, v152
    s_lshl_b32 s70, s2, 13
    s_mov_b32 s28, s8
    s_mov_b32 s29, s9
    s_mov_b32 s30, 819200
    s_cmp_lt_u32 s2, 100
    s_cbranch_scc1 k1pf_12
    s_sub_u32 s70, s70, 819200
    s_mov_b32 s28, s18
    s_mov_b32 s29, s19
    s_mov_b32 s30, 1105920
    s_cmp_ge_u32 s2, 235
    s_cselect_b32 s71, 31, s71
k1pf_12:
    s_cmp_lg_u32 s44, 4
    s_cselect_b32 s71, 31, s71
k1pf_11:
    s_mov_b32 s75, 0x20
    s_bitset1_b32 s75, s60
    s_bitset1_b32 s75, s59
    s_bitset1_b32 s75, s71
    s_mov_b32 s32, s22
    s_mov_b32 s33, s23
    s_mov_b32 s34, 0x100
    s_mov_b32 s35, 0x20000
    s_lshl_b32 s49, s45, 8
    v_lshl_add_u32 v12, v152, 2, s49
    s_lshr_b32 s49, s45, 1
    s_lshl_b32 s49, s49, 8
    s_and_b32 s50, s45, 1
    s_lshl_b32 s50, s50, 5
    s_add_u32 s49, s49, s50
    v_lshl_add_u32 v157, v155, 3, s49
    v_mov_b32 v158, 1073741824
    v_lshrrev_b32 v159, 2, v153
    v_cmp_eq_u32 vcc, v159, v154
    s_nop 1
    v_cndmask_b32 v13, v158, v157, vcc
    v_cmp_eq_u32 vcc, 0, v152
    s_nop 1
    v_cndmask_b32 v14, v158, 0, vcc
    v_mov_b32 v15, 1
    s_lshl_b32 s74, s47, 4
    s_cmp_lg_u32 s48, 15
    s_cbranch_scc1 k1zc_10w
    s_waitcnt vmcnt(0)
k1zc_10w:
    s_barrier
    s_cmp_lg_u32 s48, 15
    s_cbranch_scc1 k1inv_9
    s_cmp_lg_u32 s44, 5
    s_cbranch_scc1 k1inv_9
    buffer_store_dword v15, v14, s[32:35], s74 offen sc0 sc1
k1inv_9:
    ds_read_b128 v[104:107], v1 offset:0
    ds_read_b64_tr_b16 v[136:137], v2 offset:0
    ds_read_b64_tr_b16 v[138:139], v2 offset:512
    ds_read_b128 v[108:111], v1 offset:512
    ds_read_b64_tr_b16 v[140:141], v2 offset:4096
    ds_read_b64_tr_b16 v[142:143], v2 offset:4608
    ds_read_b128 v[112:115], v1 offset:4096
    ds_read_b64_tr_b16 v[144:145], v2 offset:8192
    ds_read_b64_tr_b16 v[146:147], v2 offset:8704
    ds_read_b128 v[116:119], v1 offset:4608
    ds_read_b64_tr_b16 v[148:149], v2 offset:12288
    ds_read_b64_tr_b16 v[150:151], v2 offset:12800
    v_xor_b32 v1, 64, v1
    v_add_u32 v2, 16384, v2
    s_cmp_ge_u32 s48, 8
    s_cbranch_scc1 k1v_13
k1loop_15:
    s_waitcnt lgkmcnt(0)
    v_mfma_f32_16x16x32_bf16 v[40:43], v[104:107], v[136:139], v[40:43]
    ds_read_b128 v[120:123], v1 offset:0
    s_add_u32 s57, s57, 0x4000
    v_mfma_f32_16x16x32_bf16 v[44:47], v[104:107], v[140:143], v[44:47]
    ds_read_b64_tr_b16 v[152:153], v2 offset:0
    s_cmp_eq_u32 s57, 0x18000
    v_mfma_f32_16x16x32_bf16 v[48:51], v[104:107], v[144:147], v[48:51]
    ds_read_b64_tr_b16 v[154:155], v2 offset:512
    s_cselect_b32 s57, 0, s57
    v_mfma_f32_16x16x32_bf16 v[52:55], v[148:151], v[104:107], v[52:55]
    ds_read_b128 v[124:127], v1 offset:512
    s_add_u32 s58, s58, 0x4000
    v_mfma_f32_16x16x32_bf16 v[56:59], v[108:111], v[136:139], v[56:59]
    ds_read_b64_tr_b16 v[156:157], v2 offset:4096
    s_cmp_eq_u32 s58, 0xc000
    v_mfma_f32_16x16x32_bf16 v[60:63], v[108:111], v[140:143], v[60:63]
    ds_read_b64_tr_b16 v[158:159], v2 offset:4608
    s_cselect_b32 s58, 0, s58
    v_mfma_f32_16x16x32_bf16 v[64:67], v[108:111], v[144:147], v[64:67]
    ds_read_b128 v[128:131], v1 offset:4096
    s_bitcmp1_b32 s75, s63
    v_mfma_f32_16x16x32_bf16 v[68:71], v[148:151], v[108:111], v[68:71]
    ds_read_b64_tr_b16 v[160:161], v2 offset:8192
    s_cbranch_scc1 k1d_16
k1d_17:
    v_mfma_f32_16x16x32_bf16 v[72:75], v[112:115], v[136:139], v[72:75]
    ds_read_b64_tr_b16 v[162:163], v2 offset:8704
    v_mfma_f32_16x16x32_bf16 v[76:79], v[112:115], v[140:143], v[76:79]
    ds_read_b128 v[132:135], v1 offset:4608
    v_mfma_f32_16x16x32_bf16 v[80:83], v[112:115], v[144:147], v[80:83]
    ds_read_b64_tr_b16 v[164:165], v2 offset:12288
    v_add_u32 v1, s58, v16
    v_mfma_f32_16x16x32_bf16 v[84:87], v[148:151], v[112:115], v[84:87]
    ds_read_b64_tr_b16 v[166:167], v2 offset:12800
    v_mfma_f32_16x16x32_bf16 v[88:91], v[116:119], v[136:139], v[88:91]
    v_add_u32 v2, s57, v17
    v_mfma_f32_16x16x32_bf16 v[92:95], v[116:119], v[140:143], v[92:95]
    v_mfma_f32_16x16x32_bf16 v[96:99], v[116:119], v[144:147], v[96:99]
    v_mfma_f32_16x16x32_bf16 v[100:103], v[148:151], v[116:119], v[100:103]
    s_waitcnt lgkmcnt(0)
    s_barrier
    v_mfma_f32_16x16x32_bf16 v[40:43], v[120:123], v[152:155], v[40:43]
    ds_read_b128 v[104:107], v1 offset:0
    s_add_u32 s57, s57, 0x4000
    v_mfma_f32_16x16x32_bf16 v[44:47], v[120:123], v[156:159], v[44:47]
    ds_read_b64_tr_b16 v[136:137], v2 offset:0
    s_cmp_eq_u32 s57, 0x18000
    v_mfma_f32_16x16x32_bf16 v[48:51], v[120:123], v[160:163], v[48:51]
    ds_read_b64_tr_b16 v[138:139], v2 offset:512
    s_cselect_b32 s57, 0, s57
    v_mfma_f32_16x16x32_bf16 v[52:55], v[164:167], v[120:123], v[52:55]
    ds_read_b128 v[108:111], v1 offset:512
    v_mfma_f32_16x16x32_bf16 v[56:59], v[124:127], v[152:155], v[56:59]
    ds_read_b64_tr_b16 v[140:141], v2 offset:4096
    v_mfma_f32_16x16x32_bf16 v[60:63], v[124:127], v[156:159], v[60:63]
    ds_read_b64_tr_b16 v[142:143], v2 offset:4608
    v_mfma_f32_16x16x32_bf16 v[64:67], v[124:127], v[160:163], v[64:67]
    ds_read_b128 v[112:115], v1 offset:4096
    s_bitcmp1_b32 s75, s63
    v_mfma_f32_16x16x32_bf16 v[68:71], v[164:167], v[124:127], v[68:71]
    ds_read_b64_tr_b16 v[144:145], v2 offset:8192
    s_cbranch_scc1 k1d_23
k1d_24:
    v_mfma_f32_16x16x32_bf16 v[72:75], v[128:131], v[152:155], v[72:75]
    ds_read_b64_tr_b16 v[146:147], v2 offset:8704
    s_add_u32 s63, s63, 1
    v_mfma_f32_16x16x32_bf16 v[76:79], v[128:131], v[156:159], v[76:79]
    ds_read_b128 v[116:119], v1 offset:4608
    s_cmp_lt_u32 s63, 10
    v_mfma_f32_16x16x32_bf16 v[80:83], v[128:131], v[160:163], v[80:83]
    ds_read_b64_tr_b16 v[148:149], v2 offset:12288
    v_xor_b32 v1, 64, v1
    v_mfma_f32_16x16x32_bf16 v[84:87], v[164:167], v[128:131], v[84:87]
    ds_read_b64_tr_b16 v[150:151], v2 offset:12800
    v_mfma_f32_16x16x32_bf16 v[88:91], v[132:135], v[152:155], v[88:91]
    v_add_u32 v2, s57, v17
    v_mfma_f32_16x16x32_bf16 v[92:95], v[132:135], v[156:159], v[92:95]
    v_mfma_f32_16x16x32_bf16 v[96:99], v[132:135], v[160:163], v[96:99]
    v_mfma_f32_16x16x32_bf16 v[100:103], v[164:167], v[132:135], v[100:103]
    s_cbranch_scc1 k1loop_15
    s_branch k1epi_14
k1d_16:
    s_cmp_eq_u32 s63, s59
    s_cbranch_scc1 k1d_18
k1d_19:
    s_cmp_eq_u32 s63, s60
    s_cbranch_scc1 k1d_20
k1d_21:
    s_cmp_lg_u32 s63, 5
    s_cbranch_scc1 k1d_17
    buffer_store_dword v24, v12, s[80:83], s61 offen sc0 sc1
    s_nop 2
    buffer_store_dwordx2 v[4:5], v13, s[80:83], s62 offen sc0 sc1
    s_branch k1d_17
k1d_23:
    s_cmp_eq_u32 s63, s59
    s_cbranch_scc1 k1d_25
k1d_26:
    s_cmp_eq_u32 s63, s60
    s_cbranch_scc1 k1d_27
k1d_28:
    s_cmp_lg_u32 s63, s71
    s_cbranch_scc1 k1d_24
    buffer_load_dword v3, s[28:31], s70 offen lds
    s_branch k1d_24
k1d_18:
    v_mfma_f32_16x16x32_bf16 v[24:27], v[20:23], v[136:139], 0
    v_mfma_f32_16x16x32_bf16 v[28:31], v[20:23], v[140:143], 0
    v_mfma_f32_16x16x32_bf16 v[32:35], v[20:23], v[144:147], 0
    v_mfma_f32_16x16x32_bf16 v[36:39], v[20:23], v[148:151], 0
    s_branch k1d_19
k1d_20:
    s_cmp_lg_u32 s45, 0
    s_cbranch_scc1 k1d_31
    v_mfma_f32_16x16x32_bf16 v[4:7], v[20:23], v[104:107], 0
    v_mfma_f32_16x16x32_bf16 v[8:11], v[104:107], v[104:107], 0
    s_branch k1d_30
k1d_31:
    s_cmp_lg_u32 s45, 1
    s_cbranch_scc1 k1d_32
    v_mfma_f32_16x16x32_bf16 v[4:7], v[20:23], v[108:111], 0
    v_mfma_f32_16x16x32_bf16 v[8:11], v[108:111], v[108:111], 0
    s_branch k1d_30
k1d_32:
    s_cmp_lg_u32 s45, 2
    s_cbranch_scc1 k1d_33
    v_mfma_f32_16x16x32_bf16 v[4:7], v[20:23], v[112:115], 0
    v_mfma_f32_16x16x32_bf16 v[8:11], v[112:115], v[112:115], 0
    s_branch k1d_30
k1d_33:
    v_mfma_f32_16x16x32_bf16 v[4:7], v[20:23], v[116:119], 0
    v_mfma_f32_16x16x32_bf16 v[8:11], v[116:119], v[116:119], 0
k1d_30:
    s_branch k1d_21
k1d_25:
    v_mfma_f32_16x16x32_bf16 v[24:27], v[20:23], v[152:155], v[24:27]
    v_mfma_f32_16x16x32_bf16 v[28:31], v[20:23], v[156:159], v[28:31]
    v_mfma_f32_16x16x32_bf16 v[32:35], v[20:23], v[160:163], v[32:35]
    v_mfma_f32_16x16x32_bf16 v[36:39], v[20:23], v[164:167], v[36:39]
    s_mov_b32 s66, 0xffff0000
    s_mov_b32 s67, 0x0
    s_mov_b32 s68, 0x0
    s_mov_b32 s69, 0xffff
    s_mov_b32 s10, 0x0
    s_mov_b32 s11, 0xffff0000
    v_cndmask_b32 v24, v24, v28, s[66:67]
    v_cndmask_b32 v24, v24, v32, s[68:69]
    v_cndmask_b32 v24, v24, v36, s[10:11]
    v_min_u32 v24, -2, v24
    s_branch k1d_26
k1d_27:
    s_cmp_lg_u32 s45, 0
    s_cbranch_scc1 k1d_36
    v_mfma_f32_16x16x32_bf16 v[4:7], v[20:23], v[120:123], v[4:7]
    v_mfma_f32_16x16x32_bf16 v[8:11], v[120:123], v[120:123], v[8:11]
    s_branch k1d_35
k1d_36:
    s_cmp_lg_u32 s45, 1
    s_cbranch_scc1 k1d_37
    v_mfma_f32_16x16x32_bf16 v[4:7], v[20:23], v[124:127], v[4:7]
    v_mfma_f32_16x16x32_bf16 v[8:11], v[124:127], v[124:127], v[8:11]
    s_branch k1d_35
k1d_37:
    s_cmp_lg_u32 s45, 2
    s_cbranch_scc1 k1d_38
    v_mfma_f32_16x16x32_bf16 v[4:7], v[20:23], v[128:131], v[4:7]
    v_mfma_f32_16x16x32_bf16 v[8:11], v[128:131], v[128:131], v[8:11]
    s_branch k1d_35
k1d_38:
    v_mfma_f32_16x16x32_bf16 v[4:7], v[20:23], v[132:135], v[4:7]
    v_mfma_f32_16x16x32_bf16 v[8:11], v[132:135], v[132:135], v[8:11]
k1d_35:
    s_mov_b32 s66, 0x22222222
    s_mov_b32 s67, 0x22222222
    s_mov_b32 s68, 0x44444444
    s_mov_b32 s69, 0x44444444
    s_mov_b32 s10, 0x88888888
    s_mov_b32 s11, 0x88888888
    s_nop 1
    v_cndmask_b32 v5, v8, v9, s[66:67]
    v_cndmask_b32 v5, v5, v10, s[68:69]
    v_cndmask_b32 v5, v5, v11, s[10:11]
    v_min_u32 v4, -2, v4
    v_min_u32 v5, -2, v5
    s_branch k1d_28
k1v_13:
k1loop_40:
    s_waitcnt lgkmcnt(0)
    v_mfma_f32_16x16x32_bf16 v[40:43], v[104:107], v[136:139], v[40:43]
    ds_read_b128 v[120:123], v1 offset:0
    s_add_u32 s57, s57, 0x4000
    v_mfma_f32_16x16x32_bf16 v[44:47], v[104:107], v[140:143], v[44:47]
    ds_read_b64_tr_b16 v[152:153], v2 offset:0
    s_cmp_eq_u32 s57, 0x18000
    v_mfma_f32_16x16x32_bf16 v[48:51], v[144:147], v[104:107], v[48:51]
    ds_read_b64_tr_b16 v[154:155], v2 offset:512
    s_cselect_b32 s57, 0, s57
    v_mfma_f32_16x16x32_bf16 v[52:55], v[148:151], v[104:107], v[52:55]
    ds_read_b128 v[124:127], v1 offset:512
    s_add_u32 s58, s58, 0x4000
    v_mfma_f32_16x16x32_bf16 v[56:59], v[108:111], v[136:139], v[56:59]
    ds_read_b64_tr_b16 v[156:157], v2 offset:4096
    s_cmp_eq_u32 s58, 0xc000
    v_mfma_f32_16x16x32_bf16 v[60:63], v[108:111], v[140:143], v[60:63]
    ds_read_b64_tr_b16 v[158:159], v2 offset:4608
    s_cselect_b32 s58, 0, s58
    v_mfma_f32_16x16x32_bf16 v[64:67], v[144:147], v[108:111], v[64:67]
    ds_read_b128 v[128:131], v1 offset:4096
    s_bitcmp1_b32 s75, s63
    v_mfma_f32_16x16x32_bf16 v[68:71], v[148:151], v[108:111], v[68:71]
    ds_read_b64_tr_b16 v[160:161], v2 offset:8192
    s_cbranch_scc1 k1d_41
k1d_42:
    v_mfma_f32_16x16x32_bf16 v[72:75], v[112:115], v[136:139], v[72:75]
    ds_read_b64_tr_b16 v[162:163], v2 offset:8704
    v_mfma_f32_16x16x32_bf16 v[76:79], v[112:115], v[140:143], v[76:79]
    ds_read_b128 v[132:135], v1 offset:4608
    v_mfma_f32_16x16x32_bf16 v[80:83], v[144:147], v[112:115], v[80:83]
    ds_read_b64_tr_b16 v[164:165], v2 offset:12288
    v_add_u32 v1, s58, v16
    v_mfma_f32_16x16x32_bf16 v[84:87], v[148:151], v[112:115], v[84:87]
    ds_read_b64_tr_b16 v[166:167], v2 offset:12800
    v_mfma_f32_16x16x32_bf16 v[88:91], v[116:119], v[136:139], v[88:91]
    v_add_u32 v2, s57, v17
    v_mfma_f32_16x16x32_bf16 v[92:95], v[116:119], v[140:143], v[92:95]
    v_mfma_f32_16x16x32_bf16 v[96:99], v[144:147], v[116:119], v[96:99]
    v_mfma_f32_16x16x32_bf16 v[100:103], v[148:151], v[116:119], v[100:103]
    s_waitcnt lgkmcnt(0)
    s_barrier
    v_mfma_f32_16x16x32_bf16 v[40:43], v[120:123], v[152:155], v[40:43]
    ds_read_b128 v[104:107], v1 offset:0
    s_add_u32 s57, s57, 0x4000
    v_mfma_f32_16x16x32_bf16 v[44:47], v[120:123], v[156:159], v[44:47]
    ds_read_b64_tr_b16 v[136:137], v2 offset:0
    s_cmp_eq_u32 s57, 0x18000
    v_mfma_f32_16x16x32_bf16 v[48:51], v[160:163], v[120:123], v[48:51]
    ds_read_b64_tr_b16 v[138:139], v2 offset:512
    s_cselect_b32 s57, 0, s57
    v_mfma_f32_16x16x32_bf16 v[52:55], v[164:167], v[120:123], v[52:55]
    ds_read_b128 v[108:111], v1 offset:512
    v_mfma_f32_16x16x32_bf16 v[56:59], v[124:127], v[152:155], v[56:59]
    ds_read_b64_tr_b16 v[140:141], v2 offset:4096
    v_mfma_f32_16x16x32_bf16 v[60:63], v[124:127], v[156:159], v[60:63]
    ds_read_b64_tr_b16 v[142:143], v2 offset:4608
    v_mfma_f32_16x16x32_bf16 v[64:67], v[160:163], v[124:127], v[64:67]
    ds_read_b128 v[112:115], v1 offset:4096
    s_bitcmp1_b32 s75, s63
    v_mfma_f32_16x16x32_bf16 v[68:71], v[164:167], v[124:127], v[68:71]
    ds_read_b64_tr_b16 v[144:145], v2 offset:8192
    s_cbranch_scc1 k1d_48
k1d_49:
    v_mfma_f32_16x16x32_bf16 v[72:75], v[128:131], v[152:155], v[72:75]
    ds_read_b64_tr_b16 v[146:147], v2 offset:8704
    s_add_u32 s63, s63, 1
    v_mfma_f32_16x16x32_bf16 v[76:79], v[128:131], v[156:159], v[76:79]
    ds_read_b128 v[116:119], v1 offset:4608
    s_cmp_lt_u32 s63, 10
    v_mfma_f32_16x16x32_bf16 v[80:83], v[160:163], v[128:131], v[80:83]
    ds_read_b64_tr_b16 v[148:149], v2 offset:12288
    v_xor_b32 v1, 64, v1
    v_mfma_f32_16x16x32_bf16 v[84:87], v[164:167], v[128:131], v[84:87]
    ds_read_b64_tr_b16 v[150:151], v2 offset:12800
    v_mfma_f32_16x16x32_bf16 v[88:91], v[132:135], v[152:155], v[88:91]
    v_add_u32 v2, s57, v17
    v_mfma_f32_16x16x32_bf16 v[92:95], v[132:135], v[156:159], v[92:95]
    v_mfma_f32_16x16x32_bf16 v[96:99], v[160:163], v[132:135], v[96:99]
    v_mfma_f32_16x16x32_bf16 v[100:103], v[164:167], v[132:135], v[100:103]
    s_cbranch_scc1 k1loop_40
    s_branch k1epi_14
k1d_41:
    s_cmp_eq_u32 s63, s59
    s_cbranch_scc1 k1d_43
k1d_44:
    s_cmp_eq_u32 s63, s60
    s_cbranch_scc1 k1d_45
k1d_46:
    s_cmp_lg_u32 s63, 5
    s_cbranch_scc1 k1d_42
    buffer_store_dword v24, v12, s[80:83], s61 offen sc0 sc1
    s_nop 2
    buffer_store_dwordx2 v[4:5], v13, s[80:83], s62 offen sc0 sc1
    s_branch k1d_42
k1d_48:
    s_cmp_eq_u32 s63, s59
    s_cbranch_scc1 k1d_50
k1d_51:
    s_cmp_eq_u32 s63, s60
    s_cbranch_scc1 k1d_52
k1d_53:
    s_cmp_lg_u32 s63, s71
    s_cbranch_scc1 k1d_49
    buffer_load_dword v3, s[28:31], s70 offen lds
    s_branch k1d_49
k1d_43:
    v_mfma_f32_16x16x32_bf16 v[24:27], v[20:23], v[136:139], 0
    v_mfma_f32_16x16x32_bf16 v[28:31], v[20:23], v[140:143], 0
    v_mfma_f32_16x16x32_bf16 v[32:35], v[20:23], v[144:147], 0
    v_mfma_f32_16x16x32_bf16 v[36:39], v[20:23], v[148:151], 0
    s_branch k1d_44
k1d_45:
    s_cmp_lg_u32 s45, 0
    s_cbranch_scc1 k1d_56
    v_mfma_f32_16x16x32_bf16 v[4:7], v[20:23], v[104:107], 0
    v_mfma_f32_16x16x32_bf16 v[8:11], v[104:107], v[104:107], 0
    s_branch k1d_55
k1d_56:
    s_cmp_lg_u32 s45, 1
    s_cbranch_scc1 k1d_57
    v_mfma_f32_16x16x32_bf16 v[4:7], v[20:23], v[108:111], 0
    v_mfma_f32_16x16x32_bf16 v[8:11], v[108:111], v[108:111], 0
    s_branch k1d_55
k1d_57:
    s_cmp_lg_u32 s45, 2
    s_cbranch_scc1 k1d_58
    v_mfma_f32_16x16x32_bf16 v[4:7], v[20:23], v[112:115], 0
    v_mfma_f32_16x16x32_bf16 v[8:11], v[112:115], v[112:115], 0
    s_branch k1d_55
k1d_58:
    v_mfma_f32_16x16x32_bf16 v[4:7], v[20:23], v[116:119], 0
    v_mfma_f32_16x16x32_bf16 v[8:11], v[116:119], v[116:119], 0
k1d_55:
    s_branch k1d_46
k1d_50:
    v_mfma_f32_16x16x32_bf16 v[24:27], v[20:23], v[152:155], v[24:27]
    v_mfma_f32_16x16x32_bf16 v[28:31], v[20:23], v[156:159], v[28:31]
    v_mfma_f32_16x16x32_bf16 v[32:35], v[20:23], v[160:163], v[32:35]
    v_mfma_f32_16x16x32_bf16 v[36:39], v[20:23], v[164:167], v[36:39]
    s_mov_b32 s66, 0xffff0000
    s_mov_b32 s67, 0x0
    s_mov_b32 s68, 0x0
    s_mov_b32 s69, 0xffff
    s_mov_b32 s10, 0x0
    s_mov_b32 s11, 0xffff0000
    v_cndmask_b32 v24, v24, v28, s[66:67]
    v_cndmask_b32 v24, v24, v32, s[68:69]
    v_cndmask_b32 v24, v24, v36, s[10:11]
    v_min_u32 v24, -2, v24
    s_branch k1d_51
k1d_52:
    s_cmp_lg_u32 s45, 0
    s_cbranch_scc1 k1d_61
    v_mfma_f32_16x16x32_bf16 v[4:7], v[20:23], v[120:123], v[4:7]
    v_mfma_f32_16x16x32_bf16 v[8:11], v[120:123], v[120:123], v[8:11]
    s_branch k1d_60
k1d_61:
    s_cmp_lg_u32 s45, 1
    s_cbranch_scc1 k1d_62
    v_mfma_f32_16x16x32_bf16 v[4:7], v[20:23], v[124:127], v[4:7]
    v_mfma_f32_16x16x32_bf16 v[8:11], v[124:127], v[124:127], v[8:11]
    s_branch k1d_60
k1d_62:
    s_cmp_lg_u32 s45, 2
    s_cbranch_scc1 k1d_63
    v_mfma_f32_16x16x32_bf16 v[4:7], v[20:23], v[128:131], v[4:7]
    v_mfma_f32_16x16x32_bf16 v[8:11], v[128:131], v[128:131], v[8:11]
    s_branch k1d_60
k1d_63:
    v_mfma_f32_16x16x32_bf16 v[4:7], v[20:23], v[132:135], v[4:7]
    v_mfma_f32_16x16x32_bf16 v[8:11], v[132:135], v[132:135], v[8:11]
k1d_60:
    s_mov_b32 s66, 0x22222222
    s_mov_b32 s67, 0x22222222
    s_mov_b32 s68, 0x44444444
    s_mov_b32 s69, 0x44444444
    s_mov_b32 s10, 0x88888888
    s_mov_b32 s11, 0x88888888
    s_nop 1
    v_cndmask_b32 v5, v8, v9, s[66:67]
    v_cndmask_b32 v5, v5, v10, s[68:69]
    v_cndmask_b32 v5, v5, v11, s[10:11]
    v_min_u32 v4, -2, v4
    v_min_u32 v5, -2, v5
    s_branch k1d_53
k1epi_14:
    s_mov_b32 s36, s24
    s_mov_b32 s37, s25
    s_mov_b32 s38, 0x5e0000
    s_mov_b32 s39, 0x20000
    v_and_b32 v6, 63, v0
    v_lshlrev_b32 v10, 4, v6
    v_and_b32 v7, 15, v0
    v_bfe_u32 v8, v0, 4, 2
    v_lshrrev_b32 v11, 2, v7
    v_and_b32 v12, 3, v7
    v_lshl_add_u32 v11, v11, 3, v12
    s_lshl_b32 s49, s46, 6
    v_add_u32 v9, s49, v11
    s_lshl_b32 s49, s46, 8
    s_add_u32 s49, s49, 147712
    v_lshl_add_u32 v11, v8, 5, s49
    s_lshl_b32 s49, s45, 8
    s_add_u32 s49, s49, 147712
    v_lshl_add_u32 v12, v7, 2, s49
    v_lshl_add_u32 v14, v8, 4, s49
    s_mov_b32 s49, 147712
    v_lshl_add_u32 v13, v9, 2, s49
    s_waitcnt lgkmcnt(0)
    s_barrier
    s_lshl_b32 s49, s47, 2
    s_lshl_b32 s50, s46, 1
    s_add_u32 s49, s49, s50
    s_mul_i32 s49, s49, 94
    s_add_u32 s49, s49, s45
    s_cmp_ge_u32 s48, 8
    s_cbranch_scc1 k1ez_65
    ds_read_b32 v144, v13 offset:512
    ds_read_b32 v140, v13 offset:0
    ds_read_b32 v145, v13 offset:528
    ds_read_b32 v141, v13 offset:16
    ds_read_b32 v146, v13 offset:640
    ds_read_b32 v142, v13 offset:128
    ds_read_b32 v147, v13 offset:656
    ds_read_b32 v143, v13 offset:144
    ds_read_b128 v[152:155], v14 offset:1216
    ds_read_b128 v[148:151], v14 offset:1152
    s_mov_b32 s32, s18
    s_mov_b32 s33, s19
    s_mov_b32 s34, 0x10e000
    s_mov_b32 s35, 0x20000
    s_lshr_b32 s50, s44, 2
    s_cmp_eq_u32 s44, 7
    s_cselect_b32 s50, 2, s50
    s_cselect_b32 s51, 0, s45
    s_lshl_b32 s52, s47, 3
    s_add_u32 s52, s52, s48
    s_mul_i32 s52, s52, 3
    s_add_u32 s52, s52, s50
    s_cmp_lg_u32 s51, 0
    s_cbranch_scc1 k1bs_67
    s_cmp_ge_u32 s52, 376
    s_cbranch_scc1 k1bs_67
    s_mul_i32 s53, s50, 5120
    s_add_u32 s53, s53, 49152
    s_lshr_b32 s63, s52, 3
    s_sub_u32 s50, s63, 20
    s_mul_i32 s50, s50, 40960
    s_mov_b32 s54, 0
    s_cmp_ge_u32 s63, 20
    s_cbranch_scc1 k1bw_68
    s_mov_b32 s32, s8
    s_mov_b32 s33, s9
    s_mov_b32 s34, 819200
    s_mul_i32 s51, s63, 52
    s_lshr_b32 s51, s51, 8
    s_mul_i32 s50, s51, 5
    s_sub_u32 s50, s63, s50
    s_cmp_eq_u32 s50, 4
    s_cselect_b32 s54, 81920, 0
    s_lshl_b32 s50, s50, 2
    s_lshr_b32 s63, 0x47520, s50
    s_and_b32 s63, s63, 15
    s_mul_i32 s51, s51, 10
    s_add_u32 s63, s63, s51
    s_mul_i32 s50, s63, 20480
k1bw_68:
    s_and_b32 s51, s52, 7
    s_mul_i32 s51, s51, 160
    s_add_u32 s50, s50, s51
    s_mov_b32 m0, s53
    v_add_u32 v15, 0, v6
    v_mul_u32_u24 v16, 205, v15
    v_lshrrev_b32 v16, 11, v16
    v_mul_u32_u24 v32, 70, v16
    v_add_lshl_u32 v15, v15, v32, 4
    v_lshrrev_b32 v16, 4, v16
    v_mad_u32_u24 v15, v16, s54, v15
    buffer_load_dwordx4 v15, s[32:35], s50 offen lds
    s_add_u32 m0, m0, 1024
    v_add_u32 v15, 64, v6
    v_mul_u32_u24 v16, 205, v15
    v_lshrrev_b32 v16, 11, v16
    v_mul_u32_u24 v32, 70, v16
    v_add_lshl_u32 v15, v15, v32, 4
    v_lshrrev_b32 v16, 4, v16
    v_mad_u32_u24 v15, v16, s54, v15
    buffer_load_dwordx4 v15, s[32:35], s50 offen lds
    s_add_u32 m0, m0, 1024
    v_add_u32 v15, 128, v6
    v_mul_u32_u24 v16, 205, v15
    v_lshrrev_b32 v16, 11, v16
    v_mul_u32_u24 v32, 70, v16
    v_add_lshl_u32 v15, v15, v32, 4
    v_lshrrev_b32 v16, 4, v16
    v_mad_u32_u24 v15, v16, s54, v15
    buffer_load_dwordx4 v15, s[32:35], s50 offen lds
    s_add_u32 m0, m0, 1024
    v_add_u32 v15, 192, v6
    v_mul_u32_u24 v16, 205, v15
    v_lshrrev_b32 v16, 11, v16
    v_mul_u32_u24 v32, 70, v16
    v_add_lshl_u32 v15, v15, v32, 4
    v_lshrrev_b32 v16, 4, v16
    v_mad_u32_u24 v15, v16, s54, v15
    buffer_load_dwordx4 v15, s[32:35], s50 offen lds
    s_add_u32 m0, m0, 1024
    v_add_u32 v15, 256, v6
    v_mul_u32_u24 v16, 205, v15
    v_lshrrev_b32 v16, 11, v16
    v_mul_u32_u24 v32, 70, v16
    v_add_lshl_u32 v15, v15, v32, 4
    v_lshrrev_b32 v16, 4, v16
    v_mad_u32_u24 v15, v16, s54, v15
    buffer_load_dwordx4 v15, s[32:35], s50 offen lds
    s_add_u32 m0, m0, 1024
k1bs_67:
    s_waitcnt lgkmcnt(0)
    ds_read_b32 v136, v12 offset:1024
    ds_read_b32 v137, v12 offset:1088
    ds_read_b32 v138, v12 offset:1152
    ds_read_b128 v[120:123], v11 offset:512
    ds_read_b128 v[104:107], v11 offset:0
    ds_read_b128 v[124:127], v11 offset:528
    ds_read_b128 v[108:111], v11 offset:16
    ds_read_b128 v[128:131], v11 offset:640
    ds_read_b128 v[112:115], v11 offset:128
    ds_read_b128 v[132:135], v11 offset:656
    ds_read_b128 v[116:119], v11 offset:144
    s_lshl_b32 s50, s48, 2
    s_add_u32 s49, s49, s50
    s_lshl_b32 s49, s49, 10
    s_add_u32 s50, s49, 96256
    s_mov_b32 s66, 0x3fb8aa3b
    s_mov_b32 s67, 0x3fb8aa3b
    s_mov_b32 s68, 0x358637bd
    s_mov_b32 s69, 0x358637bd
    v_pk_fma_f32 v[52:53], v[152:153], v[144:145], v[52:53] op_sel:[0,0,0] op_sel_hi:[1,0,1] neg_lo:[1,0,0] neg_hi:[1,0,0]
    v_pk_fma_f32 v[54:55], v[154:155], v[144:145], v[54:55] op_sel:[0,0,0] op_sel_hi:[1,0,1] neg_lo:[1,0,0] neg_hi:[1,0,0]
    v_pk_fma_f32 v[52:53], v[52:53], v[140:141], s[68:69] op_sel:[0,0,0] op_sel_hi:[1,0,1]
    v_pk_fma_f32 v[54:55], v[54:55], v[140:141], s[68:69] op_sel:[0,0,0] op_sel_hi:[1,0,1]
    v_pk_mul_f32 v[24:25], v[52:53], s[66:67]
    v_pk_mul_f32 v[26:27], v[54:55], s[66:67]
    v_exp_f32_e64 v24, v24 clamp
    v_exp_f32_e64 v25, v25 clamp
    v_exp_f32_e64 v26, v26 clamp
    v_exp_f32_e64 v27, v27 clamp
    v_max_f32 v52, s68, v52
    v_max_f32 v53, s68, v53
    v_max_f32 v54, s68, v54
    v_max_f32 v55, s68, v55
    v_pk_add_f32 v[52:53], v[52:53], v[24:25]
    v_pk_add_f32 v[54:55], v[54:55], v[26:27]
    v_cvt_pk_bf16_f32 v160, v52, v53
    v_cvt_pk_bf16_f32 v161, v54, v55
    v_pk_fma_f32 v[68:69], v[152:153], v[144:145], v[68:69] op_sel:[0,1,0] op_sel_hi:[1,1,1] neg_lo:[1,0,0] neg_hi:[1,0,0]
    v_pk_fma_f32 v[70:71], v[154:155], v[144:145], v[70:71] op_sel:[0,1,0] op_sel_hi:[1,1,1] neg_lo:[1,0,0] neg_hi:[1,0,0]
    v_pk_fma_f32 v[68:69], v[68:69], v[140:141], s[68:69] op_sel:[0,1,0] op_sel_hi:[1,1,1]
    v_pk_fma_f32 v[70:71], v[70:71], v[140:141], s[68:69] op_sel:[0,1,0] op_sel_hi:[1,1,1]
    v_pk_mul_f32 v[28:29], v[68:69], s[66:67]
    v_pk_mul_f32 v[30:31], v[70:71], s[66:67]
    v_exp_f32_e64 v28, v28 clamp
    v_exp_f32_e64 v29, v29 clamp
    v_exp_f32_e64 v30, v30 clamp
    v_exp_f32_e64 v31, v31 clamp
    v_max_f32 v68, s68, v68
    v_max_f32 v69, s68, v69
    v_max_f32 v70, s68, v70
    v_max_f32 v71, s68, v71
    v_pk_add_f32 v[68:69], v[68:69], v[28:29]
    v_pk_add_f32 v[70:71], v[70:71], v[30:31]
    v_cvt_pk_bf16_f32 v162, v68, v69
    v_cvt_pk_bf16_f32 v163, v70, v71
    buffer_store_dwordx4 v[160:163], v10, s[36:39], s49 offen sc1
    v_pk_fma_f32 v[84:85], v[152:153], v[146:147], v[84:85] op_sel:[0,0,0] op_sel_hi:[1,0,1] neg_lo:[1,0,0] neg_hi:[1,0,0]
    v_pk_fma_f32 v[86:87], v[154:155], v[146:147], v[86:87] op_sel:[0,0,0] op_sel_hi:[1,0,1] neg_lo:[1,0,0] neg_hi:[1,0,0]
    v_pk_fma_f32 v[84:85], v[84:85], v[142:143], s[68:69] op_sel:[0,0,0] op_sel_hi:[1,0,1]
    v_pk_fma_f32 v[86:87], v[86:87], v[142:143], s[68:69] op_sel:[0,0,0] op_sel_hi:[1,0,1]
    v_pk_mul_f32 v[24:25], v[84:85], s[66:67]
    v_pk_mul_f32 v[26:27], v[86:87], s[66:67]
    v_exp_f32_e64 v24, v24 clamp
    v_exp_f32_e64 v25, v25 clamp
    v_exp_f32_e64 v26, v26 clamp
    v_exp_f32_e64 v27, v27 clamp
    v_max_f32 v84, s68, v84
    v_max_f32 v85, s68, v85
    v_max_f32 v86, s68, v86
    v_max_f32 v87, s68, v87
    v_pk_add_f32 v[84:85], v[84:85], v[24:25]
    v_pk_add_f32 v[86:87], v[86:87], v[26:27]
    v_cvt_pk_bf16_f32 v164, v84, v85
    v_cvt_pk_bf16_f32 v165, v86, v87
    v_pk_fma_f32 v[100:101], v[152:153], v[146:147], v[100:101] op_sel:[0,1,0] op_sel_hi:[1,1,1] neg_lo:[1,0,0] neg_hi:[1,0,0]
    v_pk_fma_f32 v[102:103], v[154:155], v[146:147], v[102:103] op_sel:[0,1,0] op_sel_hi:[1,1,1] neg_lo:[1,0,0] neg_hi:[1,0,0]
    v_pk_fma_f32 v[100:101], v[100:101], v[142:143], s[68:69] op_sel:[0,1,0] op_sel_hi:[1,1,1]
    v_pk_fma_f32 v[102:103], v[102:103], v[142:143], s[68:69] op_sel:[0,1,0] op_sel_hi:[1,1,1]
    v_pk_mul_f32 v[28:29], v[100:101], s[66:67]
    v_pk_mul_f32 v[30:31], v[102:103], s[66:67]
    v_exp_f32_e64 v28, v28 clamp
    v_exp_f32_e64 v29, v29 clamp
    v_exp_f32_e64 v30, v30 clamp
    v_exp_f32_e64 v31, v31 clamp
    v_max_f32 v100, s68, v100
    v_max_f32 v101, s68, v101
    v_max_f32 v102, s68, v102
    v_max_f32 v103, s68, v103
    v_pk_add_f32 v[100:101], v[100:101], v[28:29]
    v_pk_add_f32 v[102:103], v[102:103], v[30:31]
    v_cvt_pk_bf16_f32 v166, v100, v101
    v_cvt_pk_bf16_f32 v167, v102, v103
    buffer_store_dwordx4 v[164:167], v10, s[36:39], s50 offen sc1
    s_lshl_b32 s49, s45, 12
    s_lshl_b32 s50, s46, 11
    s_add_u32 s49, s49, s50
    v_add_u32 v11, s49, v10
    s_and_b32 s49, s45, 1
    s_mul_i32 s49, s49, 6
    s_lshr_b32 s51, s45, 1
    s_add_u32 s49, s49, s51
    s_lshl_b32 s49, s49, 12
    s_add_u32 s49, s49, s50
    v_add_u32 v12, s49, v10
    s_waitcnt lgkmcnt(0)
    v_pk_fma_f32 v[44:45], v[120:121], v[136:137], v[44:45] op_sel:[0,1,0] op_sel_hi:[1,1,1] neg_lo:[1,0,0] neg_hi:[1,0,0]
    v_pk_fma_f32 v[46:47], v[122:123], v[136:137], v[46:47] op_sel:[0,1,0] op_sel_hi:[1,1,1] neg_lo:[1,0,0] neg_hi:[1,0,0]
    v_pk_mul_f32 v[44:45], v[44:45], v[104:105]
    v_pk_mul_f32 v[46:47], v[46:47], v[106:107]
    v_cvt_pk_bf16_f32 v160, v44, v45
    v_cvt_pk_bf16_f32 v161, v46, v47
    v_pk_fma_f32 v[60:61], v[124:125], v[136:137], v[60:61] op_sel:[0,1,0] op_sel_hi:[1,1,1] neg_lo:[1,0,0] neg_hi:[1,0,0]
    v_pk_fma_f32 v[62:63], v[126:127], v[136:137], v[62:63] op_sel:[0,1,0] op_sel_hi:[1,1,1] neg_lo:[1,0,0] neg_hi:[1,0,0]
    v_pk_mul_f32 v[60:61], v[60:61], v[108:109]
    v_pk_mul_f32 v[62:63], v[62:63], v[110:111]
    v_cvt_pk_bf16_f32 v162, v60, v61
    v_cvt_pk_bf16_f32 v163, v62, v63
    ds_write_b128 v11, v[160:163] offset:24576
    v_pk_fma_f32 v[76:77], v[128:129], v[136:137], v[76:77] op_sel:[0,1,0] op_sel_hi:[1,1,1] neg_lo:[1,0,0] neg_hi:[1,0,0]
    v_pk_fma_f32 v[78:79], v[130:131], v[136:137], v[78:79] op_sel:[0,1,0] op_sel_hi:[1,1,1] neg_lo:[1,0,0] neg_hi:[1,0,0]
    v_pk_mul_f32 v[76:77], v[76:77], v[112:113]
    v_pk_mul_f32 v[78:79], v[78:79], v[114:115]
    v_cvt_pk_bf16_f32 v164, v76, v77
    v_cvt_pk_bf16_f32 v165, v78, v79
    v_pk_fma_f32 v[92:93], v[132:133], v[136:137], v[92:93] op_sel:[0,1,0] op_sel_hi:[1,1,1] neg_lo:[1,0,0] neg_hi:[1,0,0]
    v_pk_fma_f32 v[94:95], v[134:135], v[136:137], v[94:95] op_sel:[0,1,0] op_sel_hi:[1,1,1] neg_lo:[1,0,0] neg_hi:[1,0,0]
    v_pk_mul_f32 v[92:93], v[92:93], v[116:117]
    v_pk_mul_f32 v[94:95], v[94:95], v[118:119]
    v_cvt_pk_bf16_f32 v166, v92, v93
    v_cvt_pk_bf16_f32 v167, v94, v95
    ds_write_b128 v11, v[164:167] offset:25600
    v_pk_fma_f32 v[40:41], v[120:121], v[136:137], v[40:41] op_sel:[0,0,0] op_sel_hi:[1,0,1] neg_lo:[1,0,0] neg_hi:[1,0,0]
    v_pk_fma_f32 v[42:43], v[122:123], v[136:137], v[42:43] op_sel:[0,0,0] op_sel_hi:[1,0,1] neg_lo:[1,0,0] neg_hi:[1,0,0]
    v_pk_fma_f32 v[40:41], v[40:41], v[104:105], s[68:69]
    v_pk_fma_f32 v[42:43], v[42:43], v[106:107], s[68:69]
    v_pk_mul_f32 v[148:149], v[40:41], s[66:67]
    v_pk_mul_f32 v[150:151], v[42:43], s[66:67]
    v_exp_f32_e64 v148, v148 clamp
    v_exp_f32_e64 v149, v149 clamp
    v_exp_f32_e64 v150, v150 clamp
    v_exp_f32_e64 v151, v151 clamp
    v_max_f32 v40, s68, v40
    v_max_f32 v41, s68, v41
    v_max_f32 v42, s68, v42
    v_max_f32 v43, s68, v43
    v_pk_add_f32 v[40:41], v[40:41], v[148:149]
    v_pk_add_f32 v[42:43], v[42:43], v[150:151]
    v_cvt_pk_bf16_f32 v160, v40, v41
    v_cvt_pk_bf16_f32 v161, v42, v43
    v_pk_fma_f32 v[56:57], v[124:125], v[136:137], v[56:57] op_sel:[0,0,0] op_sel_hi:[1,0,1] neg_lo:[1,0,0] neg_hi:[1,0,0]
    v_pk_fma_f32 v[58:59], v[126:127], v[136:137], v[58:59] op_sel:[0,0,0] op_sel_hi:[1,0,1] neg_lo:[1,0,0] neg_hi:[1,0,0]
    v_pk_fma_f32 v[56:57], v[56:57], v[108:109], s[68:69]
    v_pk_fma_f32 v[58:59], v[58:59], v[110:111], s[68:69]
    v_pk_mul_f32 v[152:153], v[56:57], s[66:67]
    v_pk_mul_f32 v[154:155], v[58:59], s[66:67]
    v_exp_f32_e64 v152, v152 clamp
    v_exp_f32_e64 v153, v153 clamp
    v_exp_f32_e64 v154, v154 clamp
    v_exp_f32_e64 v155, v155 clamp
    v_max_f32 v56, s68, v56
    v_max_f32 v57, s68, v57
    v_max_f32 v58, s68, v58
    v_max_f32 v59, s68, v59
    v_pk_add_f32 v[56:57], v[56:57], v[152:153]
    v_pk_add_f32 v[58:59], v[58:59], v[154:155]
    v_cvt_pk_bf16_f32 v162, v56, v57
    v_cvt_pk_bf16_f32 v163, v58, v59
    ds_write_b128 v11, v[160:163] offset:0
    v_pk_fma_f32 v[72:73], v[128:129], v[136:137], v[72:73] op_sel:[0,0,0] op_sel_hi:[1,0,1] neg_lo:[1,0,0] neg_hi:[1,0,0]
    v_pk_fma_f32 v[74:75], v[130:131], v[136:137], v[74:75] op_sel:[0,0,0] op_sel_hi:[1,0,1] neg_lo:[1,0,0] neg_hi:[1,0,0]
    v_pk_fma_f32 v[72:73], v[72:73], v[112:113], s[68:69]
    v_pk_fma_f32 v[74:75], v[74:75], v[114:115], s[68:69]
    v_pk_mul_f32 v[148:149], v[72:73], s[66:67]
    v_pk_mul_f32 v[150:151], v[74:75], s[66:67]
    v_exp_f32_e64 v148, v148 clamp
    v_exp_f32_e64 v149, v149 clamp
    v_exp_f32_e64 v150, v150 clamp
    v_exp_f32_e64 v151, v151 clamp
    v_max_f32 v72, s68, v72
    v_max_f32 v73, s68, v73
    v_max_f32 v74, s68, v74
    v_max_f32 v75, s68, v75
    v_pk_add_f32 v[72:73], v[72:73], v[148:149]
    v_pk_add_f32 v[74:75], v[74:75], v[150:151]
    v_cvt_pk_bf16_f32 v164, v72, v73
    v_cvt_pk_bf16_f32 v165, v74, v75
    v_pk_fma_f32 v[88:89], v[132:133], v[136:137], v[88:89] op_sel:[0,0,0] op_sel_hi:[1,0,1] neg_lo:[1,0,0] neg_hi:[1,0,0]
    v_pk_fma_f32 v[90:91], v[134:135], v[136:137], v[90:91] op_sel:[0,0,0] op_sel_hi:[1,0,1] neg_lo:[1,0,0] neg_hi:[1,0,0]
    v_pk_fma_f32 v[88:89], v[88:89], v[116:117], s[68:69]
    v_pk_fma_f32 v[90:91], v[90:91], v[118:119], s[68:69]
    v_pk_mul_f32 v[152:153], v[88:89], s[66:67]
    v_pk_mul_f32 v[154:155], v[90:91], s[66:67]
    v_exp_f32_e64 v152, v152 clamp
    v_exp_f32_e64 v153, v153 clamp
    v_exp_f32_e64 v154, v154 clamp
    v_exp_f32_e64 v155, v155 clamp
    v_max_f32 v88, s68, v88
    v_max_f32 v89, s68, v89
    v_max_f32 v90, s68, v90
    v_max_f32 v91, s68, v91
    v_pk_add_f32 v[88:89], v[88:89], v[152:153]
    v_pk_add_f32 v[90:91], v[90:91], v[154:155]
    v_cvt_pk_bf16_f32 v166, v88, v89
    v_cvt_pk_bf16_f32 v167, v90, v91
    ds_write_b128 v11, v[164:167] offset:1024
    s_cmp_eq_u32 s45, 0
    s_cbranch_scc1 k1k_69
    v_pk_fma_f32 v[48:49], v[120:121], v[138:139], v[48:49] op_sel:[0,0,0] op_sel_hi:[1,0,1] neg_lo:[1,0,0] neg_hi:[1,0,0]
    v_pk_fma_f32 v[50:51], v[122:123], v[138:139], v[50:51] op_sel:[0,0,0] op_sel_hi:[1,0,1] neg_lo:[1,0,0] neg_hi:[1,0,0]
    v_pk_mul_f32 v[48:49], v[48:49], v[104:105]
    v_pk_mul_f32 v[50:51], v[50:51], v[106:107]
    v_cvt_pk_bf16_f32 v160, v48, v49
    v_cvt_pk_bf16_f32 v161, v50, v51
    v_pk_fma_f32 v[64:65], v[124:125], v[138:139], v[64:65] op_sel:[0,0,0] op_sel_hi:[1,0,1] neg_lo:[1,0,0] neg_hi:[1,0,0]
    v_pk_fma_f32 v[66:67], v[126:127], v[138:139], v[66:67] op_sel:[0,0,0] op_sel_hi:[1,0,1] neg_lo:[1,0,0] neg_hi:[1,0,0]
    v_pk_mul_f32 v[64:65], v[64:65], v[108:109]
    v_pk_mul_f32 v[66:67], v[66:67], v[110:111]
    v_cvt_pk_bf16_f32 v162, v64, v65
    v_cvt_pk_bf16_f32 v163, v66, v67
    ds_write_b128 v12, v[160:163] offset:16384
    v_pk_fma_f32 v[80:81], v[128:129], v[138:139], v[80:81] op_sel:[0,0,0] op_sel_hi:[1,0,1] neg_lo:[1,0,0] neg_hi:[1,0,0]
    v_pk_fma_f32 v[82:83], v[130:131], v[138:139], v[82:83] op_sel:[0,0,0] op_sel_hi:[1,0,1] neg_lo:[1,0,0] neg_hi:[1,0,0]
    v_pk_mul_f32 v[80:81], v[80:81], v[112:113]
    v_pk_mul_f32 v[82:83], v[82:83], v[114:115]
    v_cvt_pk_bf16_f32 v164, v80, v81
    v_cvt_pk_bf16_f32 v165, v82, v83
    v_pk_fma_f32 v[96:97], v[132:133], v[138:139], v[96:97] op_sel:[0,0,0] op_sel_hi:[1,0,1] neg_lo:[1,0,0] neg_hi:[1,0,0]
    v_pk_fma_f32 v[98:99], v[134:135], v[138:139], v[98:99] op_sel:[0,0,0] op_sel_hi:[1,0,1] neg_lo:[1,0,0] neg_hi:[1,0,0]
    v_pk_mul_f32 v[96:97], v[96:97], v[116:117]
    v_pk_mul_f32 v[98:99], v[98:99], v[118:119]
    v_cvt_pk_bf16_f32 v166, v96, v97
    v_cvt_pk_bf16_f32 v167, v98, v99
    ds_write_b128 v12, v[164:167] offset:17408
    s_branch k1k_70
k1k_69:
    v_pk_fma_f32 v[48:49], v[120:121], v[138:139], v[48:49] op_sel:[0,0,0] op_sel_hi:[1,0,1] neg_lo:[1,0,0] neg_hi:[1,0,0]
    v_pk_fma_f32 v[50:51], v[122:123], v[138:139], v[50:51] op_sel:[0,0,0] op_sel_hi:[1,0,1] neg_lo:[1,0,0] neg_hi:[1,0,0]
    v_pk_fma_f32 v[48:49], v[48:49], v[104:105], s[68:69]
    v_pk_fma_f32 v[50:51], v[50:51], v[106:107], s[68:69]
    v_pk_mul_f32 v[148:149], v[48:49], s[66:67]
    v_pk_mul_f32 v[150:151], v[50:51], s[66:67]
    v_exp_f32_e64 v148, v148 clamp
    v_exp_f32_e64 v149, v149 clamp
    v_exp_f32_e64 v150, v150 clamp
    v_exp_f32_e64 v151, v151 clamp
    v_max_f32 v48, s68, v48
    v_max_f32 v49, s68, v49
    v_max_f32 v50, s68, v50
    v_max_f32 v51, s68, v51
    v_pk_add_f32 v[48:49], v[48:49], v[148:149]
    v_pk_add_f32 v[50:51], v[50:51], v[150:151]
    v_cvt_pk_bf16_f32 v160, v48, v49
    v_cvt_pk_bf16_f32 v161, v50, v51
    v_pk_fma_f32 v[64:65], v[124:125], v[138:139], v[64:65] op_sel:[0,0,0] op_sel_hi:[1,0,1] neg_lo:[1,0,0] neg_hi:[1,0,0]
    v_pk_fma_f32 v[66:67], v[126:127], v[138:139], v[66:67] op_sel:[0,0,0] op_sel_hi:[1,0,1] neg_lo:[1,0,0] neg_hi:[1,0,0]
    v_pk_fma_f32 v[64:65], v[64:65], v[108:109], s[68:69]
    v_pk_fma_f32 v[66:67], v[66:67], v[110:111], s[68:69]
    v_pk_mul_f32 v[152:153], v[64:65], s[66:67]
    v_pk_mul_f32 v[154:155], v[66:67], s[66:67]
    v_exp_f32_e64 v152, v152 clamp
    v_exp_f32_e64 v153, v153 clamp
    v_exp_f32_e64 v154, v154 clamp
    v_exp_f32_e64 v155, v155 clamp
    v_max_f32 v64, s68, v64
    v_max_f32 v65, s68, v65
    v_max_f32 v66, s68, v66
    v_max_f32 v67, s68, v67
    v_pk_add_f32 v[64:65], v[64:65], v[152:153]
    v_pk_add_f32 v[66:67], v[66:67], v[154:155]
    v_cvt_pk_bf16_f32 v162, v64, v65
    v_cvt_pk_bf16_f32 v163, v66, v67
    ds_write_b128 v12, v[160:163] offset:16384
    v_pk_fma_f32 v[80:81], v[128:129], v[138:139], v[80:81] op_sel:[0,0,0] op_sel_hi:[1,0,1] neg_lo:[1,0,0] neg_hi:[1,0,0]
    v_pk_fma_f32 v[82:83], v[130:131], v[138:139], v[82:83] op_sel:[0,0,0] op_sel_hi:[1,0,1] neg_lo:[1,0,0] neg_hi:[1,0,0]
    v_pk_fma_f32 v[80:81], v[80:81], v[112:113], s[68:69]
    v_pk_fma_f32 v[82:83], v[82:83], v[114:115], s[68:69]
    v_pk_mul_f32 v[148:149], v[80:81], s[66:67]
    v_pk_mul_f32 v[150:151], v[82:83], s[66:67]
    v_exp_f32_e64 v148, v148 clamp
    v_exp_f32_e64 v149, v149 clamp
    v_exp_f32_e64 v150, v150 clamp
    v_exp_f32_e64 v151, v151 clamp
    v_max_f32 v80, s68, v80
    v_max_f32 v81, s68, v81
    v_max_f32 v82, s68, v82
    v_max_f32 v83, s68, v83
    v_pk_add_f32 v[80:81], v[80:81], v[148:149]
    v_pk_add_f32 v[82:83], v[82:83], v[150:151]
    v_cvt_pk_bf16_f32 v164, v80, v81
    v_cvt_pk_bf16_f32 v165, v82, v83
    v_pk_fma_f32 v[96:97], v[132:133], v[138:139], v[96:97] op_sel:[0,0,0] op_sel_hi:[1,0,1] neg_lo:[1,0,0] neg_hi:[1,0,0]
    v_pk_fma_f32 v[98:99], v[134:135], v[138:139], v[98:99] op_sel:[0,0,0] op_sel_hi:[1,0,1] neg_lo:[1,0,0] neg_hi:[1,0,0]
    v_pk_fma_f32 v[96:97], v[96:97], v[116:117], s[68:69]
    v_pk_fma_f32 v[98:99], v[98:99], v[118:119], s[68:69]
    v_pk_mul_f32 v[152:153], v[96:97], s[66:67]
    v_pk_mul_f32 v[154:155], v[98:99], s[66:67]
    v_exp_f32_e64 v152, v152 clamp
    v_exp_f32_e64 v153, v153 clamp
    v_exp_f32_e64 v154, v154 clamp
    v_exp_f32_e64 v155, v155 clamp
    v_max_f32 v96, s68, v96
    v_max_f32 v97, s68, v97
    v_max_f32 v98, s68, v98
    v_max_f32 v99, s68, v99
    v_pk_add_f32 v[96:97], v[96:97], v[152:153]
    v_pk_add_f32 v[98:99], v[98:99], v[154:155]
    v_cvt_pk_bf16_f32 v166, v96, v97
    v_cvt_pk_bf16_f32 v167, v98, v99
    ds_write_b128 v12, v[164:167] offset:17408
k1k_70:
    s_add_u32 s36, s24, 0xc00000
    s_addc_u32 s37, s25, 0
    s_mov_b32 s38, 0x1e0000
    s_mov_b32 s39, 0x20000
    s_add_u32 s40, s24, 0xb20000
    s_addc_u32 s41, s25, 0
    s_mov_b32 s42, 0xa000
    s_mov_b32 s43, 0x20000
    s_waitcnt lgkmcnt(0)
    s_barrier
    s_cmp_eq_u32 s45, 0
    s_cbranch_scc1 k1b3_66
    s_cmp_eq_u32 s44, 7
    s_cbranch_scc1 k1b3_66
    s_sub_u32 s49, s44, s46
    s_sub_u32 s49, s49, 1
    s_lshl_b32 s50, s49, 12
    v_add_u32 v11, s50, v10
    ds_read_b128 v[40:43], v11 offset:0
    ds_read_b128 v[104:107], v11 offset:20480
    ds_read_b128 v[120:123], v11 offset:24576
    ds_read_b128 v[136:139], v11 offset:28672
    ds_read_b128 v[44:47], v11 offset:1024
    ds_read_b128 v[108:111], v11 offset:21504
    ds_read_b128 v[124:127], v11 offset:25600
    ds_read_b128 v[140:143], v11 offset:29696
    ds_read_b128 v[48:51], v11 offset:2048
    ds_read_b128 v[112:115], v11 offset:22528
    ds_read_b128 v[128:131], v11 offset:26624
    ds_read_b128 v[144:147], v11 offset:30720
    ds_read_b128 v[52:55], v11 offset:3072
    ds_read_b128 v[116:119], v11 offset:23552
    ds_read_b128 v[132:135], v11 offset:27648
    ds_read_b128 v[148:151], v11 offset:31744
    s_lshl_b32 s50, s47, 3
    s_add_u32 s50, s50, s48
    s_mul_i32 s50, s50, 15
    s_mul_i32 s51, s49, 3
    s_add_u32 s50, s50, s51
    s_lshl_b32 s50, s50, 10
    s_mul_i32 s63, s47, 2560
    s_mul_i32 s51, s48, 320
    s_add_u32 s63, s63, s51
    s_lshl_b32 s51, s49, 6
    s_add_u32 s63, s63, s51
    v_mov_b32 v13, 1073741824
    v_cmp_eq_u32 vcc, 0, v7
    s_nop 1
    v_cndmask_b32 v12, v13, v6, vcc
    s_waitcnt lgkmcnt(12)
    v_mfma_f32_16x16x32_bf16 v[56:59], v[40:43], v[104:107], 0
    v_mfma_f32_16x16x32_bf16 v[60:63], v[40:43], v[120:123], 0
    v_mfma_f32_16x16x32_bf16 v[64:67], v[40:43], v[136:139], 0
    v_mfma_f32_16x16x32_bf16 v[68:71], v[40:43], v[20:23], 0
    s_waitcnt lgkmcnt(8)
    v_mfma_f32_16x16x32_bf16 v[56:59], v[44:47], v[108:111], v[56:59]
    v_mfma_f32_16x16x32_bf16 v[60:63], v[44:47], v[124:127], v[60:63]
    v_mfma_f32_16x16x32_bf16 v[64:67], v[44:47], v[140:143], v[64:67]
    v_mfma_f32_16x16x32_bf16 v[68:71], v[44:47], v[20:23], v[68:71]
    s_waitcnt lgkmcnt(4)
    v_mfma_f32_16x16x32_bf16 v[56:59], v[48:51], v[112:115], v[56:59]
    v_mfma_f32_16x16x32_bf16 v[60:63], v[48:51], v[128:131], v[60:63]
    v_mfma_f32_16x16x32_bf16 v[64:67], v[48:51], v[144:147], v[64:67]
    v_mfma_f32_16x16x32_bf16 v[68:71], v[48:51], v[20:23], v[68:71]
    s_waitcnt lgkmcnt(0)
    v_mfma_f32_16x16x32_bf16 v[56:59], v[52:55], v[116:119], v[56:59]
    v_mfma_f32_16x16x32_bf16 v[60:63], v[52:55], v[132:135], v[60:63]
    v_mfma_f32_16x16x32_bf16 v[64:67], v[52:55], v[148:151], v[64:67]
    v_mfma_f32_16x16x32_bf16 v[68:71], v[52:55], v[20:23], v[68:71]
    s_nop 4
    buffer_store_dwordx4 v[56:59], v10, s[36:39], s50 offen offset:0 sc1
    buffer_store_dwordx4 v[60:63], v10, s[36:39], s50 offen offset:1024 sc1
    buffer_store_dwordx4 v[64:67], v10, s[36:39], s50 offen offset:2048 sc1
    buffer_store_dwordx4 v[68:71], v12, s[40:43], s63 offen sc1
    s_branch parallel_sum__linear_attn_block__mixer_gmlp__prompt_kernel_fin
k1ez_65:
    ds_read_b32 v136, v12 offset:1024
    ds_read_b32 v137, v12 offset:1088
    ds_read_b32 v138, v12 offset:1152
    ds_read_b128 v[120:123], v11 offset:512
    ds_read_b128 v[104:107], v11 offset:0
    ds_read_b128 v[124:127], v11 offset:528
    ds_read_b128 v[108:111], v11 offset:16
    ds_read_b128 v[128:131], v11 offset:640
    ds_read_b128 v[112:115], v11 offset:128
    ds_read_b128 v[132:135], v11 offset:656
    ds_read_b128 v[116:119], v11 offset:144
    s_lshl_b32 s50, s48, 3
    s_add_u32 s49, s49, s50
    s_cmp_eq_u32 s48, 15
    s_cselect_b32 s50, 88, 24
    s_sub_u32 s49, s49, s50
    s_lshl_b32 s52, s49, 10
    s_add_u32 s53, s52, 96256
    s_mov_b32 s68, 0xbdd2d3e8
    s_mov_b32 s69, 0xbdd2d3e8
    v_mov_b32 v4, 0xc0135761
    v_mov_b32 v5, 0xc0135761
    s_lshl_b32 s56, s48, 2
    s_add_u32 s56, s56, s45
    s_cmp_eq_u32 s48, 15
    s_cbranch_scc1 k1w_71
    s_lshl_b32 s49, s48, 3
    s_add_u32 s49, s49, s45
    s_sub_u32 s49, s49, 66
    s_lshl_b32 s49, s49, 16
    s_lshl_b32 s50, s47, 12
    s_add_u32 s49, s49, s50
    s_lshl_b32 s50, s46, 11
    s_add_u32 s54, s49, s50
    s_add_u32 s55, s54, 262144
    s_waitcnt lgkmcnt(0)
    v_pk_fma_f32 v[44:45], v[120:121], v[136:137], v[44:45] op_sel:[0,1,0] op_sel_hi:[1,1,1] neg_lo:[1,0,0] neg_hi:[1,0,0]
    v_pk_fma_f32 v[46:47], v[122:123], v[136:137], v[46:47] op_sel:[0,1,0] op_sel_hi:[1,1,1] neg_lo:[1,0,0] neg_hi:[1,0,0]
    v_pk_mul_f32 v[44:45], v[44:45], v[104:105]
    v_pk_mul_f32 v[46:47], v[46:47], v[106:107]
    v_pk_mul_f32 v[140:141], v[44:45], v[44:45]
    v_pk_mul_f32 v[142:143], v[46:47], v[46:47]
    v_pk_fma_f32 v[140:141], v[140:141], s[68:69], v[4:5]
    v_pk_fma_f32 v[142:143], v[142:143], s[68:69], v[4:5]
    v_pk_mul_f32 v[140:141], v[140:141], v[44:45]
    v_pk_mul_f32 v[142:143], v[142:143], v[46:47]
    v_exp_f32 v140, v140
    v_exp_f32 v141, v141
    v_exp_f32 v142, v142
    v_exp_f32 v143, v143
    v_pk_add_f32 v[140:141], v[140:141], 1.0 op_sel_hi:[1,0]
    v_pk_add_f32 v[142:143], v[142:143], 1.0 op_sel_hi:[1,0]
    v_rcp_f32 v140, v140
    v_rcp_f32 v141, v141
    v_rcp_f32 v142, v142
    v_rcp_f32 v143, v143
    v_pk_mul_f32 v[44:45], v[44:45], v[140:141]
    v_pk_mul_f32 v[46:47], v[46:47], v[142:143]
    v_pk_mul_f32 v[148:149], v[44:45], v[44:45]
    v_pk_mul_f32 v[150:151], v[46:47], v[46:47]
    v_pk_fma_f32 v[60:61], v[124:125], v[136:137], v[60:61] op_sel:[0,1,0] op_sel_hi:[1,1,1] neg_lo:[1,0,0] neg_hi:[1,0,0]
    v_pk_fma_f32 v[62:63], v[126:127], v[136:137], v[62:63] op_sel:[0,1,0] op_sel_hi:[1,1,1] neg_lo:[1,0,0] neg_hi:[1,0,0]
    v_pk_mul_f32 v[60:61], v[60:61], v[108:109]
    v_pk_mul_f32 v[62:63], v[62:63], v[110:111]
    v_pk_mul_f32 v[144:145], v[60:61], v[60:61]
    v_pk_mul_f32 v[146:147], v[62:63], v[62:63]
    v_pk_fma_f32 v[144:145], v[144:145], s[68:69], v[4:5]
    v_pk_fma_f32 v[146:147], v[146:147], s[68:69], v[4:5]
    v_pk_mul_f32 v[144:145], v[144:145], v[60:61]
    v_pk_mul_f32 v[146:147], v[146:147], v[62:63]
    v_exp_f32 v144, v144
    v_exp_f32 v145, v145
    v_exp_f32 v146, v146
    v_exp_f32 v147, v147
    v_pk_add_f32 v[144:145], v[144:145], 1.0 op_sel_hi:[1,0]
    v_pk_add_f32 v[146:147], v[146:147], 1.0 op_sel_hi:[1,0]
    v_rcp_f32 v144, v144
    v_rcp_f32 v145, v145
    v_rcp_f32 v146, v146
    v_rcp_f32 v147, v147
    v_pk_mul_f32 v[60:61], v[60:61], v[144:145]
    v_pk_mul_f32 v[62:63], v[62:63], v[146:147]
    v_pk_mul_f32 v[152:153], v[60:61], v[60:61]
    v_pk_mul_f32 v[154:155], v[62:63], v[62:63]
    v_pk_fma_f32 v[76:77], v[128:129], v[136:137], v[76:77] op_sel:[0,1,0] op_sel_hi:[1,1,1] neg_lo:[1,0,0] neg_hi:[1,0,0]
    v_pk_fma_f32 v[78:79], v[130:131], v[136:137], v[78:79] op_sel:[0,1,0] op_sel_hi:[1,1,1] neg_lo:[1,0,0] neg_hi:[1,0,0]
    v_pk_mul_f32 v[76:77], v[76:77], v[112:113]
    v_pk_mul_f32 v[78:79], v[78:79], v[114:115]
    v_pk_mul_f32 v[140:141], v[76:77], v[76:77]
    v_pk_mul_f32 v[142:143], v[78:79], v[78:79]
    v_pk_fma_f32 v[140:141], v[140:141], s[68:69], v[4:5]
    v_pk_fma_f32 v[142:143], v[142:143], s[68:69], v[4:5]
    v_pk_mul_f32 v[140:141], v[140:141], v[76:77]
    v_pk_mul_f32 v[142:143], v[142:143], v[78:79]
    v_exp_f32 v140, v140
    v_exp_f32 v141, v141
    v_exp_f32 v142, v142
    v_exp_f32 v143, v143
    v_pk_add_f32 v[140:141], v[140:141], 1.0 op_sel_hi:[1,0]
    v_pk_add_f32 v[142:143], v[142:143], 1.0 op_sel_hi:[1,0]
    v_rcp_f32 v140, v140
    v_rcp_f32 v141, v141
    v_rcp_f32 v142, v142
    v_rcp_f32 v143, v143
    v_pk_mul_f32 v[76:77], v[76:77], v[140:141]
    v_pk_mul_f32 v[78:79], v[78:79], v[142:143]
    v_pk_mul_f32 v[156:157], v[76:77], v[76:77]
    v_pk_mul_f32 v[158:159], v[78:79], v[78:79]
    v_pk_fma_f32 v[92:93], v[132:133], v[136:137], v[92:93] op_sel:[0,1,0] op_sel_hi:[1,1,1] neg_lo:[1,0,0] neg_hi:[1,0,0]
    v_pk_fma_f32 v[94:95], v[134:135], v[136:137], v[94:95] op_sel:[0,1,0] op_sel_hi:[1,1,1] neg_lo:[1,0,0] neg_hi:[1,0,0]
    v_pk_mul_f32 v[92:93], v[92:93], v[116:117]
    v_pk_mul_f32 v[94:95], v[94:95], v[118:119]
    v_pk_mul_f32 v[144:145], v[92:93], v[92:93]
    v_pk_mul_f32 v[146:147], v[94:95], v[94:95]
    v_pk_fma_f32 v[144:145], v[144:145], s[68:69], v[4:5]
    v_pk_fma_f32 v[146:147], v[146:147], s[68:69], v[4:5]
    v_pk_mul_f32 v[144:145], v[144:145], v[92:93]
    v_pk_mul_f32 v[146:147], v[146:147], v[94:95]
    v_exp_f32 v144, v144
    v_exp_f32 v145, v145
    v_exp_f32 v146, v146
    v_exp_f32 v147, v147
    v_pk_add_f32 v[144:145], v[144:145], 1.0 op_sel_hi:[1,0]
    v_pk_add_f32 v[146:147], v[146:147], 1.0 op_sel_hi:[1,0]
    v_rcp_f32 v144, v144
    v_rcp_f32 v145, v145
    v_rcp_f32 v146, v146
    v_rcp_f32 v147, v147
    v_pk_mul_f32 v[92:93], v[92:93], v[144:145]
    v_pk_mul_f32 v[94:95], v[94:95], v[146:147]
    v_pk_mul_f32 v[160:161], v[92:93], v[92:93]
    v_pk_mul_f32 v[162:163], v[94:95], v[94:95]
    s_cmp_lt_u32 s56, 34
    s_cbranch_scc1 k1z0_72
    v_pk_fma_f32 v[40:41], v[120:121], v[136:137], v[40:41] op_sel:[0,0,0] op_sel_hi:[1,0,1] neg_lo:[1,0,0] neg_hi:[1,0,0]
    v_pk_fma_f32 v[42:43], v[122:123], v[136:137], v[42:43] op_sel:[0,0,0] op_sel_hi:[1,0,1] neg_lo:[1,0,0] neg_hi:[1,0,0]
    v_pk_mul_f32 v[40:41], v[40:41], v[104:105]
    v_pk_mul_f32 v[42:43], v[42:43], v[106:107]
    v_pk_mul_f32 v[140:141], v[40:41], v[40:41]
    v_pk_mul_f32 v[142:143], v[42:43], v[42:43]
    v_pk_fma_f32 v[140:141], v[140:141], s[68:69], v[4:5]
    v_pk_fma_f32 v[142:143], v[142:143], s[68:69], v[4:5]
    v_pk_mul_f32 v[140:141], v[140:141], v[40:41]
    v_pk_mul_f32 v[142:143], v[142:143], v[42:43]
    v_exp_f32 v140, v140
    v_exp_f32 v141, v141
    v_exp_f32 v142, v142
    v_exp_f32 v143, v143
    v_pk_add_f32 v[140:141], v[140:141], 1.0 op_sel_hi:[1,0]
    v_pk_add_f32 v[142:143], v[142:143], 1.0 op_sel_hi:[1,0]
    v_rcp_f32 v140, v140
    v_rcp_f32 v141, v141
    v_rcp_f32 v142, v142
    v_rcp_f32 v143, v143
    v_pk_mul_f32 v[40:41], v[40:41], v[140:141]
    v_pk_mul_f32 v[42:43], v[42:43], v[142:143]
    v_pk_add_f32 v[24:25], v[44:45], v[40:41]
    v_pk_fma_f32 v[148:149], v[40:41], v[40:41], v[148:149]
    v_pk_add_f32 v[26:27], v[46:47], v[42:43]
    v_pk_fma_f32 v[150:151], v[42:43], v[42:43], v[150:151]
    v_pk_fma_f32 v[56:57], v[124:125], v[136:137], v[56:57] op_sel:[0,0,0] op_sel_hi:[1,0,1] neg_lo:[1,0,0] neg_hi:[1,0,0]
    v_pk_fma_f32 v[58:59], v[126:127], v[136:137], v[58:59] op_sel:[0,0,0] op_sel_hi:[1,0,1] neg_lo:[1,0,0] neg_hi:[1,0,0]
    v_pk_mul_f32 v[56:57], v[56:57], v[108:109]
    v_pk_mul_f32 v[58:59], v[58:59], v[110:111]
    v_pk_mul_f32 v[144:145], v[56:57], v[56:57]
    v_pk_mul_f32 v[146:147], v[58:59], v[58:59]
    v_pk_fma_f32 v[144:145], v[144:145], s[68:69], v[4:5]
    v_pk_fma_f32 v[146:147], v[146:147], s[68:69], v[4:5]
    v_pk_mul_f32 v[144:145], v[144:145], v[56:57]
    v_pk_mul_f32 v[146:147], v[146:147], v[58:59]
    v_exp_f32 v144, v144
    v_exp_f32 v145, v145
    v_exp_f32 v146, v146
    v_exp_f32 v147, v147
    v_pk_add_f32 v[144:145], v[144:145], 1.0 op_sel_hi:[1,0]
    v_pk_add_f32 v[146:147], v[146:147], 1.0 op_sel_hi:[1,0]
    v_rcp_f32 v144, v144
    v_rcp_f32 v145, v145
    v_rcp_f32 v146, v146
    v_rcp_f32 v147, v147
    v_pk_mul_f32 v[56:57], v[56:57], v[144:145]
    v_pk_mul_f32 v[58:59], v[58:59], v[146:147]
    v_pk_add_f32 v[28:29], v[60:61], v[56:57]
    v_pk_fma_f32 v[152:153], v[56:57], v[56:57], v[152:153]
    v_pk_add_f32 v[30:31], v[62:63], v[58:59]
    v_pk_fma_f32 v[154:155], v[58:59], v[58:59], v[154:155]
    v_pk_fma_f32 v[72:73], v[128:129], v[136:137], v[72:73] op_sel:[0,0,0] op_sel_hi:[1,0,1] neg_lo:[1,0,0] neg_hi:[1,0,0]
    v_pk_fma_f32 v[74:75], v[130:131], v[136:137], v[74:75] op_sel:[0,0,0] op_sel_hi:[1,0,1] neg_lo:[1,0,0] neg_hi:[1,0,0]
    v_pk_mul_f32 v[72:73], v[72:73], v[112:113]
    v_pk_mul_f32 v[74:75], v[74:75], v[114:115]
    v_pk_mul_f32 v[140:141], v[72:73], v[72:73]
    v_pk_mul_f32 v[142:143], v[74:75], v[74:75]
    v_pk_fma_f32 v[140:141], v[140:141], s[68:69], v[4:5]
    v_pk_fma_f32 v[142:143], v[142:143], s[68:69], v[4:5]
    v_pk_mul_f32 v[140:141], v[140:141], v[72:73]
    v_pk_mul_f32 v[142:143], v[142:143], v[74:75]
    v_exp_f32 v140, v140
    v_exp_f32 v141, v141
    v_exp_f32 v142, v142
    v_exp_f32 v143, v143
    v_pk_add_f32 v[140:141], v[140:141], 1.0 op_sel_hi:[1,0]
    v_pk_add_f32 v[142:143], v[142:143], 1.0 op_sel_hi:[1,0]
    v_rcp_f32 v140, v140
    v_rcp_f32 v141, v141
    v_rcp_f32 v142, v142
    v_rcp_f32 v143, v143
    v_pk_mul_f32 v[72:73], v[72:73], v[140:141]
    v_pk_mul_f32 v[74:75], v[74:75], v[142:143]
    v_pk_add_f32 v[32:33], v[76:77], v[72:73]
    v_pk_fma_f32 v[156:157], v[72:73], v[72:73], v[156:157]
    v_pk_add_f32 v[34:35], v[78:79], v[74:75]
    v_pk_fma_f32 v[158:159], v[74:75], v[74:75], v[158:159]
    v_pk_fma_f32 v[88:89], v[132:133], v[136:137], v[88:89] op_sel:[0,0,0] op_sel_hi:[1,0,1] neg_lo:[1,0,0] neg_hi:[1,0,0]
    v_pk_fma_f32 v[90:91], v[134:135], v[136:137], v[90:91] op_sel:[0,0,0] op_sel_hi:[1,0,1] neg_lo:[1,0,0] neg_hi:[1,0,0]
    v_pk_mul_f32 v[88:89], v[88:89], v[116:117]
    v_pk_mul_f32 v[90:91], v[90:91], v[118:119]
    v_pk_mul_f32 v[144:145], v[88:89], v[88:89]
    v_pk_mul_f32 v[146:147], v[90:91], v[90:91]
    v_pk_fma_f32 v[144:145], v[144:145], s[68:69], v[4:5]
    v_pk_fma_f32 v[146:147], v[146:147], s[68:69], v[4:5]
    v_pk_mul_f32 v[144:145], v[144:145], v[88:89]
    v_pk_mul_f32 v[146:147], v[146:147], v[90:91]
    v_exp_f32 v144, v144
    v_exp_f32 v145, v145
    v_exp_f32 v146, v146
    v_exp_f32 v147, v147
    v_pk_add_f32 v[144:145], v[144:145], 1.0 op_sel_hi:[1,0]
    v_pk_add_f32 v[146:147], v[146:147], 1.0 op_sel_hi:[1,0]
    v_rcp_f32 v144, v144
    v_rcp_f32 v145, v145
    v_rcp_f32 v146, v146
    v_rcp_f32 v147, v147
    v_pk_mul_f32 v[88:89], v[88:89], v[144:145]
    v_pk_mul_f32 v[90:91], v[90:91], v[146:147]
    v_pk_add_f32 v[36:37], v[92:93], v[88:89]
    v_pk_fma_f32 v[160:161], v[88:89], v[88:89], v[160:161]
    v_pk_add_f32 v[38:39], v[94:95], v[90:91]
    v_pk_fma_f32 v[162:163], v[90:91], v[90:91], v[162:163]
    s_branch k1z1_73
k1z0_72:
    v_mov_b32 v24, v44
    v_mov_b32 v25, v45
    v_mov_b32 v26, v46
    v_mov_b32 v27, v47
    v_mov_b32 v28, v60
    v_mov_b32 v29, v61
    v_mov_b32 v30, v62
    v_mov_b32 v31, v63
    v_mov_b32 v32, v76
    v_mov_b32 v33, v77
    v_mov_b32 v34, v78
    v_mov_b32 v35, v79
    v_mov_b32 v36, v92
    v_mov_b32 v37, v93
    v_mov_b32 v38, v94
    v_mov_b32 v39, v95
k1z1_73:
    v_add_f32_dpp v24, v24, v24 row_ror:8 row_mask:0xf bank_mask:0x3
    v_add_f32_dpp v25, v25, v25 row_ror:8 row_mask:0xf bank_mask:0x3
    v_add_f32_dpp v26, v26, v26 row_ror:8 row_mask:0xf bank_mask:0x3
    v_add_f32_dpp v27, v27, v27 row_ror:8 row_mask:0xf bank_mask:0x3
    v_add_f32_dpp v28, v28, v28 row_ror:8 row_mask:0xf bank_mask:0x3
    v_add_f32_dpp v29, v29, v29 row_ror:8 row_mask:0xf bank_mask:0x3
    v_add_f32_dpp v30, v30, v30 row_ror:8 row_mask:0xf bank_mask:0x3
    v_add_f32_dpp v31, v31, v31 row_ror:8 row_mask:0xf bank_mask:0x3
    v_add_f32_dpp v32, v32, v32 row_ror:8 row_mask:0xf bank_mask:0x3
    v_add_f32_dpp v33, v33, v33 row_ror:8 row_mask:0xf bank_mask:0x3
    v_add_f32_dpp v34, v34, v34 row_ror:8 row_mask:0xf bank_mask:0x3
    v_add_f32_dpp v35, v35, v35 row_ror:8 row_mask:0xf bank_mask:0x3
    v_add_f32_dpp v36, v36, v36 row_ror:8 row_mask:0xf bank_mask:0x3
    v_add_f32_dpp v37, v37, v37 row_ror:8 row_mask:0xf bank_mask:0x3
    v_add_f32_dpp v38, v38, v38 row_ror:8 row_mask:0xf bank_mask:0x3
    v_add_f32_dpp v39, v39, v39 row_ror:8 row_mask:0xf bank_mask:0x3
    v_add_f32_dpp v24, v148, v148 row_ror:8 row_mask:0xf bank_mask:0xc
    v_add_f32_dpp v25, v149, v149 row_ror:8 row_mask:0xf bank_mask:0xc
    v_add_f32_dpp v26, v150, v150 row_ror:8 row_mask:0xf bank_mask:0xc
    v_add_f32_dpp v27, v151, v151 row_ror:8 row_mask:0xf bank_mask:0xc
    v_add_f32_dpp v28, v152, v152 row_ror:8 row_mask:0xf bank_mask:0xc
    v_add_f32_dpp v29, v153, v153 row_ror:8 row_mask:0xf bank_mask:0xc
    v_add_f32_dpp v30, v154, v154 row_ror:8 row_mask:0xf bank_mask:0xc
    v_add_f32_dpp v31, v155, v155 row_ror:8 row_mask:0xf bank_mask:0xc
    v_add_f32_dpp v32, v156, v156 row_ror:8 row_mask:0xf bank_mask:0xc
    v_add_f32_dpp v33, v157, v157 row_ror:8 row_mask:0xf bank_mask:0xc
    v_add_f32_dpp v34, v158, v158 row_ror:8 row_mask:0xf bank_mask:0xc
    v_add_f32_dpp v35, v159, v159 row_ror:8 row_mask:0xf bank_mask:0xc
    v_add_f32_dpp v36, v160, v160 row_ror:8 row_mask:0xf bank_mask:0xc
    v_add_f32_dpp v37, v161, v161 row_ror:8 row_mask:0xf bank_mask:0xc
    v_add_f32_dpp v38, v162, v162 row_ror:8 row_mask:0xf bank_mask:0xc
    v_add_f32_dpp v39, v163, v163 row_ror:8 row_mask:0xf bank_mask:0xc
    v_add_f32_dpp v24, v24, v24 row_shl:4 row_mask:0xf bank_mask:0x5
    v_add_f32_dpp v25, v25, v25 row_shl:4 row_mask:0xf bank_mask:0x5
    v_add_f32_dpp v26, v26, v26 row_shl:4 row_mask:0xf bank_mask:0x5
    v_add_f32_dpp v27, v27, v27 row_shl:4 row_mask:0xf bank_mask:0x5
    v_add_f32_dpp v28, v28, v28 row_shl:4 row_mask:0xf bank_mask:0x5
    v_add_f32_dpp v29, v29, v29 row_shl:4 row_mask:0xf bank_mask:0x5
    v_add_f32_dpp v30, v30, v30 row_shl:4 row_mask:0xf bank_mask:0x5
    v_add_f32_dpp v31, v31, v31 row_shl:4 row_mask:0xf bank_mask:0x5
    v_add_f32_dpp v24, v32, v32 row_shr:4 row_mask:0xf bank_mask:0xa
    v_add_f32_dpp v25, v33, v33 row_shr:4 row_mask:0xf bank_mask:0xa
    v_add_f32_dpp v26, v34, v34 row_shr:4 row_mask:0xf bank_mask:0xa
    v_add_f32_dpp v27, v35, v35 row_shr:4 row_mask:0xf bank_mask:0xa
    v_add_f32_dpp v28, v36, v36 row_shr:4 row_mask:0xf bank_mask:0xa
    v_add_f32_dpp v29, v37, v37 row_shr:4 row_mask:0xf bank_mask:0xa
    v_add_f32_dpp v30, v38, v38 row_shr:4 row_mask:0xf bank_mask:0xa
    v_add_f32_dpp v31, v39, v39 row_shr:4 row_mask:0xf bank_mask:0xa
    v_add_f32_dpp v24, v24, v24 quad_perm:[1,0,3,2] row_mask:0xf bank_mask:0xf
    v_add_f32_dpp v25, v25, v25 quad_perm:[1,0,3,2] row_mask:0xf bank_mask:0xf
    v_add_f32_dpp v26, v26, v26 quad_perm:[1,0,3,2] row_mask:0xf bank_mask:0xf
    v_add_f32_dpp v27, v27, v27 quad_perm:[1,0,3,2] row_mask:0xf bank_mask:0xf
    v_add_f32_dpp v28, v28, v28 quad_perm:[1,0,3,2] row_mask:0xf bank_mask:0xf
    v_add_f32_dpp v29, v29, v29 quad_perm:[1,0,3,2] row_mask:0xf bank_mask:0xf
    v_add_f32_dpp v30, v30, v30 quad_perm:[1,0,3,2] row_mask:0xf bank_mask:0xf
    v_add_f32_dpp v31, v31, v31 quad_perm:[1,0,3,2] row_mask:0xf bank_mask:0xf
    v_add_f32_dpp v24, v24, v24 quad_perm:[2,3,0,1] row_mask:0xf bank_mask:0xf
    v_add_f32_dpp v25, v25, v25 quad_perm:[2,3,0,1] row_mask:0xf bank_mask:0xf
    v_add_f32_dpp v26, v26, v26 quad_perm:[2,3,0,1] row_mask:0xf bank_mask:0xf
    v_add_f32_dpp v27, v27, v27 quad_perm:[2,3,0,1] row_mask:0xf bank_mask:0xf
    v_add_f32_dpp v28, v28, v28 quad_perm:[2,3,0,1] row_mask:0xf bank_mask:0xf
    v_add_f32_dpp v29, v29, v29 quad_perm:[2,3,0,1] row_mask:0xf bank_mask:0xf
    v_add_f32_dpp v30, v30, v30 quad_perm:[2,3,0,1] row_mask:0xf bank_mask:0xf
    v_add_f32_dpp v31, v31, v31 quad_perm:[2,3,0,1] row_mask:0xf bank_mask:0xf
    v_bfe_u32 v104, v6, 3, 1
    v_lshlrev_b32 v104, 9, v104
    v_bfe_u32 v105, v6, 2, 1
    v_lshl_add_u32 v104, v105, 7, v104
    v_lshl_add_u32 v104, v8, 5, v104
    s_lshl_b32 s49, s45, 10
    s_lshl_b32 s50, s46, 8
    s_add_u32 s49, s49, s50
    v_add_u32 v104, s49, v104
    ds_write_b128 v104, v[24:27] offset:0
    ds_write_b128 v104, v[28:31] offset:16
    s_waitcnt lgkmcnt(0)
    s_barrier
k1w_71:
    ds_read_b32 v144, v13 offset:512
    ds_read_b32 v140, v13 offset:0
    ds_read_b32 v145, v13 offset:528
    ds_read_b32 v141, v13 offset:16
    ds_read_b32 v146, v13 offset:640
    ds_read_b32 v142, v13 offset:128
    ds_read_b32 v147, v13 offset:656
    ds_read_b32 v143, v13 offset:144
    ds_read_b128 v[152:155], v14 offset:1216
    ds_read_b128 v[148:151], v14 offset:1152
    s_waitcnt lgkmcnt(0)
    s_cmp_lg_u32 s48, 15
    s_cbranch_scc1 k1wq_79
    s_mov_b32 s66, 0x3fb8aa3b
    s_mov_b32 s67, 0x3fb8aa3b
    s_mov_b32 s68, 0x358637bd
    s_mov_b32 s69, 0x358637bd
    v_pk_fma_f32 v[48:49], v[148:149], v[144:145], v[48:49] op_sel:[0,0,0] op_sel_hi:[1,0,1] neg_lo:[1,0,0] neg_hi:[1,0,0]
    v_pk_fma_f32 v[50:51], v[150:151], v[144:145], v[50:51] op_sel:[0,0,0] op_sel_hi:[1,0,1] neg_lo:[1,0,0] neg_hi:[1,0,0]
    v_pk_fma_f32 v[48:49], v[48:49], v[140:141], s[68:69] op_sel:[0,0,0] op_sel_hi:[1,0,1]
    v_pk_fma_f32 v[50:51], v[50:51], v[140:141], s[68:69] op_sel:[0,0,0] op_sel_hi:[1,0,1]
    v_pk_mul_f32 v[24:25], v[48:49], s[66:67]
    v_pk_mul_f32 v[26:27], v[50:51], s[66:67]
    v_exp_f32_e64 v24, v24 clamp
    v_exp_f32_e64 v25, v25 clamp
    v_exp_f32_e64 v26, v26 clamp
    v_exp_f32_e64 v27, v27 clamp
    v_max_f32 v48, s68, v48
    v_max_f32 v49, s68, v49
    v_max_f32 v50, s68, v50
    v_max_f32 v51, s68, v51
    v_pk_add_f32 v[48:49], v[48:49], v[24:25]
    v_pk_add_f32 v[50:51], v[50:51], v[26:27]
    v_cvt_pk_bf16_f32 v160, v48, v49
    v_cvt_pk_bf16_f32 v161, v50, v51
    v_pk_fma_f32 v[64:65], v[148:149], v[144:145], v[64:65] op_sel:[0,1,0] op_sel_hi:[1,1,1] neg_lo:[1,0,0] neg_hi:[1,0,0]
    v_pk_fma_f32 v[66:67], v[150:151], v[144:145], v[66:67] op_sel:[0,1,0] op_sel_hi:[1,1,1] neg_lo:[1,0,0] neg_hi:[1,0,0]
    v_pk_fma_f32 v[64:65], v[64:65], v[140:141], s[68:69] op_sel:[0,1,0] op_sel_hi:[1,1,1]
    v_pk_fma_f32 v[66:67], v[66:67], v[140:141], s[68:69] op_sel:[0,1,0] op_sel_hi:[1,1,1]
    v_pk_mul_f32 v[28:29], v[64:65], s[66:67]
    v_pk_mul_f32 v[30:31], v[66:67], s[66:67]
    v_exp_f32_e64 v28, v28 clamp
    v_exp_f32_e64 v29, v29 clamp
    v_exp_f32_e64 v30, v30 clamp
    v_exp_f32_e64 v31, v31 clamp
    v_max_f32 v64, s68, v64
    v_max_f32 v65, s68, v65
    v_max_f32 v66, s68, v66
    v_max_f32 v67, s68, v67
    v_pk_add_f32 v[64:65], v[64:65], v[28:29]
    v_pk_add_f32 v[66:67], v[66:67], v[30:31]
    v_cvt_pk_bf16_f32 v162, v64, v65
    v_cvt_pk_bf16_f32 v163, v66, v67
    buffer_store_dwordx4 v[160:163], v10, s[36:39], s52 offen sc1
    v_pk_fma_f32 v[80:81], v[148:149], v[146:147], v[80:81] op_sel:[0,0,0] op_sel_hi:[1,0,1] neg_lo:[1,0,0] neg_hi:[1,0,0]
    v_pk_fma_f32 v[82:83], v[150:151], v[146:147], v[82:83] op_sel:[0,0,0] op_sel_hi:[1,0,1] neg_lo:[1,0,0] neg_hi:[1,0,0]
    v_pk_fma_f32 v[80:81], v[80:81], v[142:143], s[68:69] op_sel:[0,0,0] op_sel_hi:[1,0,1]
    v_pk_fma_f32 v[82:83], v[82:83], v[142:143], s[68:69] op_sel:[0,0,0] op_sel_hi:[1,0,1]
    v_pk_mul_f32 v[24:25], v[80:81], s[66:67]
    v_pk_mul_f32 v[26:27], v[82:83], s[66:67]
    v_exp_f32_e64 v24, v24 clamp
    v_exp_f32_e64 v25, v25 clamp
    v_exp_f32_e64 v26, v26 clamp
    v_exp_f32_e64 v27, v27 clamp
    v_max_f32 v80, s68, v80
    v_max_f32 v81, s68, v81
    v_max_f32 v82, s68, v82
    v_max_f32 v83, s68, v83
    v_pk_add_f32 v[80:81], v[80:81], v[24:25]
    v_pk_add_f32 v[82:83], v[82:83], v[26:27]
    v_cvt_pk_bf16_f32 v164, v80, v81
    v_cvt_pk_bf16_f32 v165, v82, v83
    v_pk_fma_f32 v[96:97], v[148:149], v[146:147], v[96:97] op_sel:[0,1,0] op_sel_hi:[1,1,1] neg_lo:[1,0,0] neg_hi:[1,0,0]
    v_pk_fma_f32 v[98:99], v[150:151], v[146:147], v[98:99] op_sel:[0,1,0] op_sel_hi:[1,1,1] neg_lo:[1,0,0] neg_hi:[1,0,0]
    v_pk_fma_f32 v[96:97], v[96:97], v[142:143], s[68:69] op_sel:[0,1,0] op_sel_hi:[1,1,1]
    v_pk_fma_f32 v[98:99], v[98:99], v[142:143], s[68:69] op_sel:[0,1,0] op_sel_hi:[1,1,1]
    v_pk_mul_f32 v[28:29], v[96:97], s[66:67]
    v_pk_mul_f32 v[30:31], v[98:99], s[66:67]
    v_exp_f32_e64 v28, v28 clamp
    v_exp_f32_e64 v29, v29 clamp
    v_exp_f32_e64 v30, v30 clamp
    v_exp_f32_e64 v31, v31 clamp
    v_max_f32 v96, s68, v96
    v_max_f32 v97, s68, v97
    v_max_f32 v98, s68, v98
    v_max_f32 v99, s68, v99
    v_pk_add_f32 v[96:97], v[96:97], v[28:29]
    v_pk_add_f32 v[98:99], v[98:99], v[30:31]
    v_cvt_pk_bf16_f32 v166, v96, v97
    v_cvt_pk_bf16_f32 v167, v98, v99
    buffer_store_dwordx4 v[164:167], v10, s[36:39], s53 offen sc1
    s_add_u32 s52, s52, 4096
    s_add_u32 s53, s53, 4096
    v_pk_fma_f32 v[52:53], v[152:153], v[144:145], v[52:53] op_sel:[0,0,0] op_sel_hi:[1,0,1] neg_lo:[1,0,0] neg_hi:[1,0,0]
    v_pk_fma_f32 v[54:55], v[154:155], v[144:145], v[54:55] op_sel:[0,0,0] op_sel_hi:[1,0,1] neg_lo:[1,0,0] neg_hi:[1,0,0]
    v_pk_fma_f32 v[52:53], v[52:53], v[140:141], s[68:69] op_sel:[0,0,0] op_sel_hi:[1,0,1]
    v_pk_fma_f32 v[54:55], v[54:55], v[140:141], s[68:69] op_sel:[0,0,0] op_sel_hi:[1,0,1]
    v_pk_mul_f32 v[24:25], v[52:53], s[66:67]
    v_pk_mul_f32 v[26:27], v[54:55], s[66:67]
    v_exp_f32_e64 v24, v24 clamp
    v_exp_f32_e64 v25, v25 clamp
    v_exp_f32_e64 v26, v26 clamp
    v_exp_f32_e64 v27, v27 clamp
    v_max_f32 v52, s68, v52
    v_max_f32 v53, s68, v53
    v_max_f32 v54, s68, v54
    v_max_f32 v55, s68, v55
    v_pk_add_f32 v[52:53], v[52:53], v[24:25]
    v_pk_add_f32 v[54:55], v[54:55], v[26:27]
    v_cvt_pk_bf16_f32 v160, v52, v53
    v_cvt_pk_bf16_f32 v161, v54, v55
    v_pk_fma_f32 v[68:69], v[152:153], v[144:145], v[68:69] op_sel:[0,1,0] op_sel_hi:[1,1,1] neg_lo:[1,0,0] neg_hi:[1,0,0]
    v_pk_fma_f32 v[70:71], v[154:155], v[144:145], v[70:71] op_sel:[0,1,0] op_sel_hi:[1,1,1] neg_lo:[1,0,0] neg_hi:[1,0,0]
    v_pk_fma_f32 v[68:69], v[68:69], v[140:141], s[68:69] op_sel:[0,1,0] op_sel_hi:[1,1,1]
    v_pk_fma_f32 v[70:71], v[70:71], v[140:141], s[68:69] op_sel:[0,1,0] op_sel_hi:[1,1,1]
    v_pk_mul_f32 v[28:29], v[68:69], s[66:67]
    v_pk_mul_f32 v[30:31], v[70:71], s[66:67]
    v_exp_f32_e64 v28, v28 clamp
    v_exp_f32_e64 v29, v29 clamp
    v_exp_f32_e64 v30, v30 clamp
    v_exp_f32_e64 v31, v31 clamp
    v_max_f32 v68, s68, v68
    v_max_f32 v69, s68, v69
    v_max_f32 v70, s68, v70
    v_max_f32 v71, s68, v71
    v_pk_add_f32 v[68:69], v[68:69], v[28:29]
    v_pk_add_f32 v[70:71], v[70:71], v[30:31]
    v_cvt_pk_bf16_f32 v162, v68, v69
    v_cvt_pk_bf16_f32 v163, v70, v71
    buffer_store_dwordx4 v[160:163], v10, s[36:39], s52 offen sc1
    v_pk_fma_f32 v[84:85], v[152:153], v[146:147], v[84:85] op_sel:[0,0,0] op_sel_hi:[1,0,1] neg_lo:[1,0,0] neg_hi:[1,0,0]
    v_pk_fma_f32 v[86:87], v[154:155], v[146:147], v[86:87] op_sel:[0,0,0] op_sel_hi:[1,0,1] neg_lo:[1,0,0] neg_hi:[1,0,0]
    v_pk_fma_f32 v[84:85], v[84:85], v[142:143], s[68:69] op_sel:[0,0,0] op_sel_hi:[1,0,1]
    v_pk_fma_f32 v[86:87], v[86:87], v[142:143], s[68:69] op_sel:[0,0,0] op_sel_hi:[1,0,1]
    v_pk_mul_f32 v[24:25], v[84:85], s[66:67]
    v_pk_mul_f32 v[26:27], v[86:87], s[66:67]
    v_exp_f32_e64 v24, v24 clamp
    v_exp_f32_e64 v25, v25 clamp
    v_exp_f32_e64 v26, v26 clamp
    v_exp_f32_e64 v27, v27 clamp
    v_max_f32 v84, s68, v84
    v_max_f32 v85, s68, v85
    v_max_f32 v86, s68, v86
    v_max_f32 v87, s68, v87
    v_pk_add_f32 v[84:85], v[84:85], v[24:25]
    v_pk_add_f32 v[86:87], v[86:87], v[26:27]
    v_cvt_pk_bf16_f32 v164, v84, v85
    v_cvt_pk_bf16_f32 v165, v86, v87
    v_pk_fma_f32 v[100:101], v[152:153], v[146:147], v[100:101] op_sel:[0,1,0] op_sel_hi:[1,1,1] neg_lo:[1,0,0] neg_hi:[1,0,0]
    v_pk_fma_f32 v[102:103], v[154:155], v[146:147], v[102:103] op_sel:[0,1,0] op_sel_hi:[1,1,1] neg_lo:[1,0,0] neg_hi:[1,0,0]
    v_pk_fma_f32 v[100:101], v[100:101], v[142:143], s[68:69] op_sel:[0,1,0] op_sel_hi:[1,1,1]
    v_pk_fma_f32 v[102:103], v[102:103], v[142:143], s[68:69] op_sel:[0,1,0] op_sel_hi:[1,1,1]
    v_pk_mul_f32 v[28:29], v[100:101], s[66:67]
    v_pk_mul_f32 v[30:31], v[102:103], s[66:67]
    v_exp_f32_e64 v28, v28 clamp
    v_exp_f32_e64 v29, v29 clamp
    v_exp_f32_e64 v30, v30 clamp
    v_exp_f32_e64 v31, v31 clamp
    v_max_f32 v100, s68, v100
    v_max_f32 v101, s68, v101
    v_max_f32 v102, s68, v102
    v_max_f32 v103, s68, v103
    v_pk_add_f32 v[100:101], v[100:101], v[28:29]
    v_pk_add_f32 v[102:103], v[102:103], v[30:31]
    v_cvt_pk_bf16_f32 v166, v100, v101
    v_cvt_pk_bf16_f32 v167, v102, v103
    buffer_store_dwordx4 v[164:167], v10, s[36:39], s53 offen sc1
    s_branch parallel_sum__linear_attn_block__mixer_gmlp__prompt_kernel_fin
k1wq_79:
    v_pk_fma_f32 v[48:49], v[148:149], v[144:145], v[48:49] op_sel:[0,0,0] op_sel_hi:[1,0,1] neg_lo:[1,0,0] neg_hi:[1,0,0]
    v_pk_fma_f32 v[50:51], v[150:151], v[144:145], v[50:51] op_sel:[0,0,0] op_sel_hi:[1,0,1] neg_lo:[1,0,0] neg_hi:[1,0,0]
    v_pk_mul_f32 v[48:49], v[48:49], v[140:141] op_sel:[0,0] op_sel_hi:[1,0]
    v_pk_mul_f32 v[50:51], v[50:51], v[140:141] op_sel:[0,0] op_sel_hi:[1,0]
    v_cvt_pk_bf16_f32 v160, v48, v49
    v_cvt_pk_bf16_f32 v161, v50, v51
    v_pk_fma_f32 v[64:65], v[148:149], v[144:145], v[64:65] op_sel:[0,1,0] op_sel_hi:[1,1,1] neg_lo:[1,0,0] neg_hi:[1,0,0]
    v_pk_fma_f32 v[66:67], v[150:151], v[144:145], v[66:67] op_sel:[0,1,0] op_sel_hi:[1,1,1] neg_lo:[1,0,0] neg_hi:[1,0,0]
    v_pk_mul_f32 v[64:65], v[64:65], v[140:141] op_sel:[0,1] op_sel_hi:[1,1]
    v_pk_mul_f32 v[66:67], v[66:67], v[140:141] op_sel:[0,1] op_sel_hi:[1,1]
    v_cvt_pk_bf16_f32 v162, v64, v65
    v_cvt_pk_bf16_f32 v163, v66, v67
    buffer_store_dwordx4 v[160:163], v10, s[36:39], s52 offen sc1
    v_pk_fma_f32 v[80:81], v[148:149], v[146:147], v[80:81] op_sel:[0,0,0] op_sel_hi:[1,0,1] neg_lo:[1,0,0] neg_hi:[1,0,0]
    v_pk_fma_f32 v[82:83], v[150:151], v[146:147], v[82:83] op_sel:[0,0,0] op_sel_hi:[1,0,1] neg_lo:[1,0,0] neg_hi:[1,0,0]
    v_pk_mul_f32 v[80:81], v[80:81], v[142:143] op_sel:[0,0] op_sel_hi:[1,0]
    v_pk_mul_f32 v[82:83], v[82:83], v[142:143] op_sel:[0,0] op_sel_hi:[1,0]
    v_cvt_pk_bf16_f32 v164, v80, v81
    v_cvt_pk_bf16_f32 v165, v82, v83
    v_pk_fma_f32 v[96:97], v[148:149], v[146:147], v[96:97] op_sel:[0,1,0] op_sel_hi:[1,1,1] neg_lo:[1,0,0] neg_hi:[1,0,0]
    v_pk_fma_f32 v[98:99], v[150:151], v[146:147], v[98:99] op_sel:[0,1,0] op_sel_hi:[1,1,1] neg_lo:[1,0,0] neg_hi:[1,0,0]
    v_pk_mul_f32 v[96:97], v[96:97], v[142:143] op_sel:[0,1] op_sel_hi:[1,1]
    v_pk_mul_f32 v[98:99], v[98:99], v[142:143] op_sel:[0,1] op_sel_hi:[1,1]
    v_cvt_pk_bf16_f32 v166, v96, v97
    v_cvt_pk_bf16_f32 v167, v98, v99
    buffer_store_dwordx4 v[164:167], v10, s[36:39], s53 offen sc1
    s_add_u32 s52, s52, 4096
    s_add_u32 s53, s53, 4096
    s_cmp_ge_u32 s56, 58
    s_cbranch_scc1 k1wq_80
    v_pk_fma_f32 v[52:53], v[152:153], v[144:145], v[52:53] op_sel:[0,0,0] op_sel_hi:[1,0,1] neg_lo:[1,0,0] neg_hi:[1,0,0]
    v_pk_fma_f32 v[54:55], v[154:155], v[144:145], v[54:55] op_sel:[0,0,0] op_sel_hi:[1,0,1] neg_lo:[1,0,0] neg_hi:[1,0,0]
    v_pk_mul_f32 v[52:53], v[52:53], v[140:141] op_sel:[0,0] op_sel_hi:[1,0]
    v_pk_mul_f32 v[54:55], v[54:55], v[140:141] op_sel:[0,0] op_sel_hi:[1,0]
    v_cvt_pk_bf16_f32 v160, v52, v53
    v_cvt_pk_bf16_f32 v161, v54, v55
    v_pk_fma_f32 v[68:69], v[152:153], v[144:145], v[68:69] op_sel:[0,1,0] op_sel_hi:[1,1,1] neg_lo:[1,0,0] neg_hi:[1,0,0]
    v_pk_fma_f32 v[70:71], v[154:155], v[144:145], v[70:71] op_sel:[0,1,0] op_sel_hi:[1,1,1] neg_lo:[1,0,0] neg_hi:[1,0,0]
    v_pk_mul_f32 v[68:69], v[68:69], v[140:141] op_sel:[0,1] op_sel_hi:[1,1]
    v_pk_mul_f32 v[70:71], v[70:71], v[140:141] op_sel:[0,1] op_sel_hi:[1,1]
    v_cvt_pk_bf16_f32 v162, v68, v69
    v_cvt_pk_bf16_f32 v163, v70, v71
    buffer_store_dwordx4 v[160:163], v10, s[36:39], s52 offen sc1
    v_pk_fma_f32 v[84:85], v[152:153], v[146:147], v[84:85] op_sel:[0,0,0] op_sel_hi:[1,0,1] neg_lo:[1,0,0] neg_hi:[1,0,0]
    v_pk_fma_f32 v[86:87], v[154:155], v[146:147], v[86:87] op_sel:[0,0,0] op_sel_hi:[1,0,1] neg_lo:[1,0,0] neg_hi:[1,0,0]
    v_pk_mul_f32 v[84:85], v[84:85], v[142:143] op_sel:[0,0] op_sel_hi:[1,0]
    v_pk_mul_f32 v[86:87], v[86:87], v[142:143] op_sel:[0,0] op_sel_hi:[1,0]
    v_cvt_pk_bf16_f32 v164, v84, v85
    v_cvt_pk_bf16_f32 v165, v86, v87
    v_pk_fma_f32 v[100:101], v[152:153], v[146:147], v[100:101] op_sel:[0,1,0] op_sel_hi:[1,1,1] neg_lo:[1,0,0] neg_hi:[1,0,0]
    v_pk_fma_f32 v[102:103], v[154:155], v[146:147], v[102:103] op_sel:[0,1,0] op_sel_hi:[1,1,1] neg_lo:[1,0,0] neg_hi:[1,0,0]
    v_pk_mul_f32 v[100:101], v[100:101], v[142:143] op_sel:[0,1] op_sel_hi:[1,1]
    v_pk_mul_f32 v[102:103], v[102:103], v[142:143] op_sel:[0,1] op_sel_hi:[1,1]
    v_cvt_pk_bf16_f32 v166, v100, v101
    v_cvt_pk_bf16_f32 v167, v102, v103
    buffer_store_dwordx4 v[164:167], v10, s[36:39], s53 offen sc1
k1wq_80:
    s_add_u32 s36, s24, 0x700000
    s_addc_u32 s37, s25, 0
    s_mov_b32 s38, 0x360000
    s_mov_b32 s39, 0x20000
    s_barrier
    ds_read_b128 v[120:123], v11 offset:2560
    ds_read_b128 v[104:107], v11 offset:2048
    ds_read_b128 v[124:127], v11 offset:2576
    ds_read_b128 v[108:111], v11 offset:2064
    ds_read_b128 v[128:131], v11 offset:2688
    ds_read_b128 v[112:115], v11 offset:2176
    ds_read_b128 v[132:135], v11 offset:2704
    ds_read_b128 v[116:119], v11 offset:2192
    s_waitcnt lgkmcnt(6)
    v_pk_fma_f32 v[44:45], v[44:45], v[104:105], v[120:121] neg_lo:[0,0,1] neg_hi:[0,0,1]
    v_pk_fma_f32 v[46:47], v[46:47], v[106:107], v[122:123] neg_lo:[0,0,1] neg_hi:[0,0,1]
    v_cvt_pk_bf16_f32 v160, v44, v45
    v_cvt_pk_bf16_f32 v161, v46, v47
    s_waitcnt lgkmcnt(4)
    v_pk_fma_f32 v[60:61], v[60:61], v[108:109], v[124:125] neg_lo:[0,0,1] neg_hi:[0,0,1]
    v_pk_fma_f32 v[62:63], v[62:63], v[110:111], v[126:127] neg_lo:[0,0,1] neg_hi:[0,0,1]
    v_cvt_pk_bf16_f32 v162, v60, v61
    v_cvt_pk_bf16_f32 v163, v62, v63
    buffer_store_dwordx4 v[160:163], v10, s[36:39], s55 offen offset:0 sc1
    s_waitcnt lgkmcnt(2)
    v_pk_fma_f32 v[76:77], v[76:77], v[112:113], v[128:129] neg_lo:[0,0,1] neg_hi:[0,0,1]
    v_pk_fma_f32 v[78:79], v[78:79], v[114:115], v[130:131] neg_lo:[0,0,1] neg_hi:[0,0,1]
    v_cvt_pk_bf16_f32 v164, v76, v77
    v_cvt_pk_bf16_f32 v165, v78, v79
    s_waitcnt lgkmcnt(0)
    v_pk_fma_f32 v[92:93], v[92:93], v[116:117], v[132:133] neg_lo:[0,0,1] neg_hi:[0,0,1]
    v_pk_fma_f32 v[94:95], v[94:95], v[118:119], v[134:135] neg_lo:[0,0,1] neg_hi:[0,0,1]
    v_cvt_pk_bf16_f32 v166, v92, v93
    v_cvt_pk_bf16_f32 v167, v94, v95
    buffer_store_dwordx4 v[164:167], v10, s[36:39], s55 offen offset:1024 sc1
    s_cmp_lt_u32 s56, 34
    s_cbranch_scc1 parallel_sum__linear_attn_block__mixer_gmlp__prompt_kernel_fin
    v_pk_fma_f32 v[40:41], v[40:41], v[104:105], v[120:121] neg_lo:[0,0,1] neg_hi:[0,0,1]
    v_pk_fma_f32 v[42:43], v[42:43], v[106:107], v[122:123] neg_lo:[0,0,1] neg_hi:[0,0,1]
    v_cvt_pk_bf16_f32 v160, v40, v41
    v_cvt_pk_bf16_f32 v161, v42, v43
    v_pk_fma_f32 v[56:57], v[56:57], v[108:109], v[124:125] neg_lo:[0,0,1] neg_hi:[0,0,1]
    v_pk_fma_f32 v[58:59], v[58:59], v[110:111], v[126:127] neg_lo:[0,0,1] neg_hi:[0,0,1]
    v_cvt_pk_bf16_f32 v162, v56, v57
    v_cvt_pk_bf16_f32 v163, v58, v59
    buffer_store_dwordx4 v[160:163], v10, s[36:39], s54 offen offset:0 sc1
    v_pk_fma_f32 v[72:73], v[72:73], v[112:113], v[128:129] neg_lo:[0,0,1] neg_hi:[0,0,1]
    v_pk_fma_f32 v[74:75], v[74:75], v[114:115], v[130:131] neg_lo:[0,0,1] neg_hi:[0,0,1]
    v_cvt_pk_bf16_f32 v164, v72, v73
    v_cvt_pk_bf16_f32 v165, v74, v75
    v_pk_fma_f32 v[88:89], v[88:89], v[116:117], v[132:133] neg_lo:[0,0,1] neg_hi:[0,0,1]
    v_pk_fma_f32 v[90:91], v[90:91], v[118:119], v[134:135] neg_lo:[0,0,1] neg_hi:[0,0,1]
    v_cvt_pk_bf16_f32 v166, v88, v89
    v_cvt_pk_bf16_f32 v167, v90, v91
    buffer_store_dwordx4 v[164:167], v10, s[36:39], s54 offen offset:1024 sc1
    s_branch parallel_sum__linear_attn_block__mixer_gmlp__prompt_kernel_fin
k1b3_66:
    s_add_u32 s40, s24, 0x1800000
    s_addc_u32 s41, s25, 0
    s_mov_b32 s42, 0x1d6000
    s_mov_b32 s43, 0x20000
    s_cmp_ge_u32 s52, 376
    s_cbranch_scc1 parallel_sum__linear_attn_block__mixer_gmlp__prompt_kernel_fin
    v_bfe_u32 v12, v6, 2, 4
    v_mul_u32_u24 v12, 160, v12
    v_add_u32 v12, s53, v12
    v_and_b32 v13, 3, v6
    v_lshl_add_u32 v14, v13, 3, v12
    v_lshl_add_u32 v12, v13, 4, v12
    s_and_b32 s50, s52, 7
    s_mul_i32 s50, s50, 47
    s_lshr_b32 s51, s52, 3
    s_add_u32 s50, s50, s51
    s_mul_i32 s50, s50, 5120
    s_add_u32 s51, s50, 4096
    s_waitcnt vmcnt(2)
    ds_read_b64_tr_b16 v[40:41], v12 offset:0
    ds_read_b64_tr_b16 v[42:43], v12 offset:2560
    ds_read_b64_tr_b16 v[44:45], v12 offset:8
    ds_read_b64_tr_b16 v[46:47], v12 offset:2568
    ds_read_b64_tr_b16 v[48:49], v12 offset:64
    ds_read_b64_tr_b16 v[50:51], v12 offset:2624
    ds_read_b64_tr_b16 v[52:53], v12 offset:72
    ds_read_b64_tr_b16 v[54:55], v12 offset:2632
    ds_read_b64_tr_b16 v[56:57], v14 offset:128
    ds_read_b64_tr_b16 v[58:59], v14 offset:2688
    s_waitcnt lgkmcnt(8)
    buffer_store_dwordx4 v[40:43], v10, s[40:43], s50 offen offset:0 sc1
    s_waitcnt lgkmcnt(6)
    buffer_store_dwordx4 v[44:47], v10, s[40:43], s50 offen offset:1024 sc1
    s_waitcnt lgkmcnt(4)
    buffer_store_dwordx4 v[48:51], v10, s[40:43], s50 offen offset:2048 sc1
    s_waitcnt lgkmcnt(2)
    buffer_store_dwordx4 v[52:55], v10, s[40:43], s50 offen offset:3072 sc1
    s_waitcnt lgkmcnt(0)
    buffer_store_dwordx4 v[56:59], v10, s[40:43], s51 offen offset:0 sc1
parallel_sum__linear_attn_block__mixer_gmlp__prompt_kernel_fin:
    s_add_u32 s36, s24, 0xb40000
    s_addc_u32 s37, s25, 0
    s_mov_b32 s38, 0x3800
    s_mov_b32 s39, 0x20000
    s_sub_u32 s50, s48, 8
    s_lshl_b32 s49, s50, 2
    s_add_u32 s49, s49, 28
    v_xor_b32 v11, 4, v6
    v_add_u32 v11, s49, v11
    v_lshlrev_b32 v11, 7, v11
    s_cmp_eq_u32 s50, 0
    s_cselect_b32 s51, 4, 8
    s_cmp_ge_u32 s50, 7
    s_cselect_b32 s51, 0, s51
    v_mov_b32 v12, 1073741824
    v_cmp_gt_u32 vcc, s51, v6
    s_nop 1
    v_cndmask_b32 v11, v12, v11, vcc
    s_add_u32 s49, s48, 64
    s_lshl_b32 s49, s49, 7
    v_mov_b32 v12, s49
    s_cmp_eq_u32 s51, 0
    s_cselect_b32 s51, 8, 64
    v_cmp_eq_u32 vcc, s51, v6
    s_nop 1
    v_cndmask_b32 v11, v11, v12, vcc
    v_subrev_u32 v13, 16, v6
    v_sub_u32 v14, s50, v13
    v_lshrrev_b32 v15, 1, v14
    v_and_b32 v15, 2, v15
    s_lshr_b32 s49, s47, 2
    v_xor_b32 v15, s49, v15
    v_lshl_add_u32 v15, v14, 2, v15
    v_add_u32 v15, 80, v15
    v_lshlrev_b32 v15, 7, v15
    s_cmp_eq_u32 s50, 0
    s_cselect_b32 s49, 1, 2
    s_cmp_ge_u32 s50, 7
    s_cselect_b32 s49, 0, s49
    v_cmp_gt_u32 vcc, s49, v13
    s_nop 1
    v_cndmask_b32 v11, v11, v15, vcc
    v_mov_b32 v12, 1
    s_waitcnt vmcnt(0)
    s_barrier
    s_cmp_lg_u32 s44, 1
    s_cbranch_scc1 parallel_sum__linear_attn_block__mixer_gmlp__prompt_kernel_p2
    buffer_atomic_add v12, v11, s[36:39], 0 offen sc1
    s_branch parallel_sum__linear_attn_block__mixer_gmlp__prompt_kernel_p2
parallel_sum__linear_attn_block__mixer_gmlp__prompt_kernel_p2:
    v_lshrrev_b32 v3, 6, v0
    v_and_b32 v1, 63, v0
    v_readfirstlane_b32 s52, v3
    v_lshlrev_b32 v1, 4, v1
    v_mov_b32 v2, 0
    s_and_b32 s57, s2, 6
    s_lshl_b32 s55, s57, 2
    s_lshr_b32 s58, s2, 5
    s_add_u32 s55, s55, s58
    s_bfe_u32 s56, s2, 0x20003
    s_xor_b32 s56, s56, 3
    s_and_b32 s59, s2, 1
    s_lshl_b32 s58, s59, 2
    s_add_u32 s56, s56, s58
    s_add_u32 s57, s57, s58
    s_and_b32 s57, s57, 7
    s_lshl_b32 s62, s57, 9
    s_lshl_b32 s63, s57, 13
    s_and_b32 s53, s52, 3
    s_lshr_b32 s54, s52, 2
    s_lshl_b32 s71, s55, 7
    s_mov_b32 s72, 0xffff0000
    s_cmp_eq_u32 s54, 2
    s_cbranch_scc1 k2load_95
    s_cmp_eq_u32 s56, 7
    s_cbranch_scc1 k2side_93
    s_lshl_b32 s61, s56, 3
    s_lshl_b32 s58, s53, 1
    s_add_u32 s61, s61, s58
    s_lshl_b32 s58, s61, 16
    s_lshl_b32 s59, s54, 11
    s_add_u32 s58, s58, s59
    v_add_u32 v8, s58, v1
    v_add_u32 v9, 0x10000, v8
    s_waitcnt lgkmcnt(0)
    s_add_u32 s28, s24, 0x700000
    s_addc_u32 s29, s25, 0
    s_mov_b32 s30, 0x360000
    s_mov_b32 s31, 0x20000
    s_mov_b32 s32, s24
    s_mov_b32 s33, s25
    s_mov_b32 s34, 0x5e0000
    s_mov_b32 s35, 0x20000
    s_mov_b32 s36, s16
    s_mov_b32 s37, s17
    s_mov_b32 s38, 0x1000
    s_mov_b32 s39, 0x20000
    s_add_u32 s44, s24, 0xe00000
    s_addc_u32 s45, s25, 0
    s_mov_b32 s46, 0x5e0000
    s_mov_b32 s47, 0x20000
    s_add_u32 s48, s24, 0xb40000
    s_addc_u32 s49, s25, 0
    s_mov_b32 s50, 0x3800
    s_mov_b32 s51, 0x20000
    v_and_b32 v92, 15, v0
    v_bfe_u32 v96, v0, 4, 2
    v_lshrrev_b32 v93, 2, v92
    v_and_b32 v94, 3, v92
    v_lshl_add_u32 v95, v93, 3, v94
    s_lshl_b32 s58, s54, 5
    v_add_u32 v95, s58, v95
    s_lshl_b32 s58, s54, 3
    v_add_u32 v93, s58, v96
    v_xor_b32 v93, v93, v92
    v_lshlrev_b32 v93, 4, v93
    v_lshl_add_u32 v4, v95, 8, v93
    v_add_u32 v4, 65536, v4
    v_xor_b32 v5, 0x2000, v4
    v_xor_b32 v6, 64, v4
    v_xor_b32 v7, 64, v5
    v_lshlrev_b32 v76, 1, v95
    s_mov_b32 s74, 1.0
    s_mov_b32 s75, 1.0
    s_mov_b32 s76, 0xbdd2d3e8
    s_mov_b32 s77, 0xbdd2d3e8
    v_mov_b32 v10, 0xc0135761
    v_mov_b32 v11, 0xc0135761
    s_lshl_b32 s60, s55, 1
    s_add_u32 s60, s60, s54
    s_mul_i32 s60, s60, 94
    s_add_u32 s60, s60, s61
    s_add_u32 s60, s60, 40
    s_lshl_b32 s60, s60, 10
    s_cmp_ge_u32 s61, 54
    s_cselect_b32 s60, s34, s60
    s_lshl_b32 s61, s55, 7
    v_mov_b32 v3, 150784
    ds_write_b32 v3, v2
    s_lshl_b32 s66, s55, 2
    s_add_u32 s66, s66, s53
    s_mul_i32 s66, s66, 47
    s_add_u32 s66, s66, s54
    s_lshl_b32 s66, s66, 10
    s_cmp_lg_u32 s52, 0
    s_cbranch_scc1 k2g_98
    s_lshl_b32 s57, s56, 2
    s_lshr_b32 s58, s55, 3
    s_add_u32 s57, s57, s58
    s_add_u32 s57, s57, 80
    s_lshl_b32 s57, s57, 7
    s_cmp_eq_u32 s56, 6
    s_cselect_b32 s58, 4, 8
    s_mov_b32 s64, 0
pp_101:
    buffer_load_dword v156, v2, s[48:51], s57 offen sc1
    s_add_u32 s64, s64, 1
    s_waitcnt vmcnt(0)
    v_cmp_eq_u32 vcc, 0, v156
    s_cmp_ge_u32 s64, 262144
    s_cbranch_scc1 pp_100
    s_cbranch_vccz pp_102
    s_sleep 12
    s_branch pp_101
pp_102:
    v_cmp_gt_u32 vcc, s58, v156
    s_nop 1
    s_cbranch_vccz pp_100
    buffer_load_dword v156, v2, s[48:51], s57 offen sc1
    s_sleep 4
pp_99:
    buffer_load_dword v157, v2, s[48:51], s57 offen sc1
    s_waitcnt vmcnt(1)
    v_cmp_gt_u32 vcc, s58, v156
    s_nop 1
    s_cbranch_vccz pp_100
    s_sleep 2
    buffer_load_dword v156, v2, s[48:51], s57 offen sc1
    s_waitcnt vmcnt(1)
    v_cmp_gt_u32 vcc, s58, v157
    s_nop 1
    s_cbranch_vccz pp_100
    s_sleep 2
    s_add_u32 s64, s64, 1
    s_cmp_lt_u32 s64, 262144
    s_cbranch_scc1 pp_99
pp_100:
k2g_98:
    s_barrier
    buffer_load_dwordx4 v[12:15], v8, s[28:31], s63 offen offset:0
    buffer_load_dwordx4 v[16:19], v9, s[28:31], s63 offen offset:0
    buffer_load_dwordx4 v[20:23], v8, s[28:31], s63 offen offset:1024
    buffer_load_dwordx4 v[24:27], v9, s[28:31], s63 offen offset:1024
    s_add_u32 s63, s63, 4096
    s_and_b32 s63, s63, 0xffff
    buffer_load_dwordx4 v[28:31], v8, s[28:31], s63 offen offset:0
    buffer_load_dwordx4 v[32:35], v9, s[28:31], s63 offen offset:0
    buffer_load_dwordx4 v[36:39], v8, s[28:31], s63 offen offset:1024
    buffer_load_dwordx4 v[40:43], v9, s[28:31], s63 offen offset:1024
    s_add_u32 s63, s63, 4096
    s_and_b32 s63, s63, 0xffff
    buffer_load_dwordx4 v[44:47], v8, s[28:31], s63 offen offset:0
    buffer_load_dwordx4 v[48:51], v9, s[28:31], s63 offen offset:0
    buffer_load_dwordx4 v[52:55], v8, s[28:31], s63 offen offset:1024
    buffer_load_dwordx4 v[56:59], v9, s[28:31], s63 offen offset:1024
    s_add_u32 s63, s63, 4096
    s_and_b32 s63, s63, 0xffff
    ds_read_b128 v[124:127], v4 offset:0
    ds_read_b128 v[128:131], v4 offset:1024
    ds_read_b128 v[132:135], v5 offset:0
    ds_read_b128 v[136:139], v5 offset:1024
    s_waitcnt vmcnt(8) lgkmcnt(0)
    s_barrier
    v_mfma_f32_16x16x32_bf16 v[92:95], v[12:15], v[124:127], 0
    ds_read_b128 v[140:143], v6 offset:0
    v_mfma_f32_16x16x32_bf16 v[96:99], v[16:19], v[124:127], 0
    ds_read_b128 v[144:147], v6 offset:1024
    buffer_load_dwordx4 v[60:63], v8, s[28:31], s63 offen offset:0
    v_mfma_f32_16x16x32_bf16 v[100:103], v[12:15], v[128:131], 0
    ds_read_b128 v[148:151], v7 offset:0
    v_mfma_f32_16x16x32_bf16 v[104:107], v[16:19], v[128:131], 0
    ds_read_b128 v[152:155], v7 offset:1024
    v_mfma_f32_16x16x32_bf16 v[108:111], v[12:15], v[132:135], 0
    buffer_load_dwordx4 v[64:67], v9, s[28:31], s63 offen offset:0
    v_mfma_f32_16x16x32_bf16 v[112:115], v[16:19], v[132:135], 0
    v_mfma_f32_16x16x32_bf16 v[116:119], v[12:15], v[136:139], 0
    v_mfma_f32_16x16x32_bf16 v[120:123], v[16:19], v[136:139], 0
    buffer_load_dwordx4 v[68:71], v8, s[28:31], s63 offen offset:1024
    s_waitcnt lgkmcnt(0)
    v_mfma_f32_16x16x32_bf16 v[92:95], v[20:23], v[140:143], v[92:95]
    ds_read_b128 v[124:127], v4 offset:16384
    v_mfma_f32_16x16x32_bf16 v[96:99], v[24:27], v[140:143], v[96:99]
    ds_read_b128 v[128:131], v4 offset:17408
    v_mfma_f32_16x16x32_bf16 v[100:103], v[20:23], v[144:147], v[100:103]
    ds_read_b128 v[132:135], v5 offset:16384
    buffer_load_dwordx4 v[72:75], v9, s[28:31], s63 offen offset:1024
    s_add_u32 s63, s63, 4096
    s_and_b32 s63, s63, 0xffff
    v_mfma_f32_16x16x32_bf16 v[104:107], v[24:27], v[144:147], v[104:107]
    ds_read_b128 v[136:139], v5 offset:17408
    v_mfma_f32_16x16x32_bf16 v[108:111], v[20:23], v[148:151], v[108:111]
    v_mfma_f32_16x16x32_bf16 v[112:115], v[24:27], v[148:151], v[112:115]
    v_mfma_f32_16x16x32_bf16 v[116:119], v[20:23], v[152:155], v[116:119]
    v_mfma_f32_16x16x32_bf16 v[120:123], v[24:27], v[152:155], v[120:123]
    s_waitcnt vmcnt(8) lgkmcnt(0)
    s_barrier
    v_mfma_f32_16x16x32_bf16 v[92:95], v[28:31], v[124:127], v[92:95]
    ds_read_b128 v[140:143], v6 offset:16384
    buffer_load_dwordx4 v[12:15], v8, s[28:31], s63 offen offset:0
    v_mfma_f32_16x16x32_bf16 v[96:99], v[32:35], v[124:127], v[96:99]
    ds_read_b128 v[144:147], v6 offset:17408
    buffer_load_dwordx4 v[16:19], v9, s[28:31], s63 offen offset:0
    v_mfma_f32_16x16x32_bf16 v[100:103], v[28:31], v[128:131], v[100:103]
    ds_read_b128 v[148:151], v7 offset:16384
    buffer_load_dwordx4 v[20:23], v8, s[28:31], s63 offen offset:1024
    v_mfma_f32_16x16x32_bf16 v[104:107], v[32:35], v[128:131], v[104:107]
    ds_read_b128 v[152:155], v7 offset:17408
    buffer_load_dwordx4 v[24:27], v9, s[28:31], s63 offen offset:1024
    s_add_u32 s63, s63, 4096
    s_and_b32 s63, s63, 0xffff
    v_mfma_f32_16x16x32_bf16 v[108:111], v[28:31], v[132:135], v[108:111]
    buffer_load_dwordx4 v[156:159], v1, s[32:35], s60 offen offset:0
    v_mfma_f32_16x16x32_bf16 v[112:115], v[32:35], v[132:135], v[112:115]
    v_mfma_f32_16x16x32_bf16 v[116:119], v[28:31], v[136:139], v[116:119]
    v_mfma_f32_16x16x32_bf16 v[120:123], v[32:35], v[136:139], v[120:123]
    buffer_load_dwordx4 v[160:163], v1, s[32:35], s60 offen offset:1024
    s_waitcnt lgkmcnt(0)
    v_mfma_f32_16x16x32_bf16 v[92:95], v[36:39], v[140:143], v[92:95]
    ds_read_b128 v[124:127], v4 offset:32768
    v_mfma_f32_16x16x32_bf16 v[96:99], v[40:43], v[140:143], v[96:99]
    ds_read_b128 v[128:131], v4 offset:33792
    v_mfma_f32_16x16x32_bf16 v[100:103], v[36:39], v[144:147], v[100:103]
    ds_read_b128 v[132:135], v5 offset:32768
    buffer_load_ushort v164, v76, s[36:39], s61 offen offset:0
    v_mfma_f32_16x16x32_bf16 v[104:107], v[40:43], v[144:147], v[104:107]
    ds_read_b128 v[136:139], v5 offset:33792
    v_mfma_f32_16x16x32_bf16 v[108:111], v[36:39], v[148:151], v[108:111]
    v_mfma_f32_16x16x32_bf16 v[112:115], v[40:43], v[148:151], v[112:115]
    buffer_load_ushort v165, v76, s[36:39], s61 offen offset:8
    v_mfma_f32_16x16x32_bf16 v[116:119], v[36:39], v[152:155], v[116:119]
    v_mfma_f32_16x16x32_bf16 v[120:123], v[40:43], v[152:155], v[120:123]
    s_waitcnt vmcnt(12) lgkmcnt(0)
    s_barrier
    v_mfma_f32_16x16x32_bf16 v[92:95], v[44:47], v[124:127], v[92:95]
    ds_read_b128 v[140:143], v6 offset:32768
    v_mfma_f32_16x16x32_bf16 v[96:99], v[48:51], v[124:127], v[96:99]
    ds_read_b128 v[144:147], v6 offset:33792
    buffer_load_dwordx4 v[28:31], v8, s[28:31], s63 offen offset:0
    v_mfma_f32_16x16x32_bf16 v[100:103], v[44:47], v[128:131], v[100:103]
    ds_read_b128 v[148:151], v7 offset:32768
    v_mfma_f32_16x16x32_bf16 v[104:107], v[48:51], v[128:131], v[104:107]
    ds_read_b128 v[152:155], v7 offset:33792
    v_mfma_f32_16x16x32_bf16 v[108:111], v[44:47], v[132:135], v[108:111]
    buffer_load_dwordx4 v[32:35], v9, s[28:31], s63 offen offset:0
    v_mfma_f32_16x16x32_bf16 v[112:115], v[48:51], v[132:135], v[112:115]
    v_mfma_f32_16x16x32_bf16 v[116:119], v[44:47], v[136:139], v[116:119]
    v_mfma_f32_16x16x32_bf16 v[120:123], v[48:51], v[136:139], v[120:123]
    buffer_load_dwordx4 v[36:39], v8, s[28:31], s63 offen offset:1024
    s_waitcnt lgkmcnt(0)
    v_mfma_f32_16x16x32_bf16 v[92:95], v[52:55], v[140:143], v[92:95]
    ds_read_b128 v[124:127], v4 offset:49152
    v_mfma_f32_16x16x32_bf16 v[96:99], v[56:59], v[140:143], v[96:99]
    ds_read_b128 v[128:131], v4 offset:50176
    v_mfma_f32_16x16x32_bf16 v[100:103], v[52:55], v[144:147], v[100:103]
    ds_read_b128 v[132:135], v5 offset:49152
    buffer_load_dwordx4 v[40:43], v9, s[28:31], s63 offen offset:1024
    s_add_u32 s63, s63, 4096
    s_and_b32 s63, s63, 0xffff
    v_mfma_f32_16x16x32_bf16 v[104:107], v[56:59], v[144:147], v[104:107]
    ds_read_b128 v[136:139], v5 offset:50176
    v_mfma_f32_16x16x32_bf16 v[108:111], v[52:55], v[148:151], v[108:111]
    v_mfma_f32_16x16x32_bf16 v[112:115], v[56:59], v[148:151], v[112:115]
    v_mfma_f32_16x16x32_bf16 v[116:119], v[52:55], v[152:155], v[116:119]
    v_mfma_f32_16x16x32_bf16 v[120:123], v[56:59], v[152:155], v[120:123]
    s_waitcnt vmcnt(12) lgkmcnt(0)
    s_barrier
    v_mfma_f32_16x16x32_bf16 v[92:95], v[60:63], v[124:127], v[92:95]
    ds_read_b128 v[140:143], v6 offset:49152
    v_mfma_f32_16x16x32_bf16 v[96:99], v[64:67], v[124:127], v[96:99]
    ds_read_b128 v[144:147], v6 offset:50176
    buffer_load_dwordx4 v[44:47], v8, s[28:31], s63 offen offset:0
    v_mfma_f32_16x16x32_bf16 v[100:103], v[60:63], v[128:131], v[100:103]
    ds_read_b128 v[148:151], v7 offset:49152
    v_mfma_f32_16x16x32_bf16 v[104:107], v[64:67], v[128:131], v[104:107]
    ds_read_b128 v[152:155], v7 offset:50176
    v_mfma_f32_16x16x32_bf16 v[108:111], v[60:63], v[132:135], v[108:111]
    buffer_load_dwordx4 v[48:51], v9, s[28:31], s63 offen offset:0
    v_mfma_f32_16x16x32_bf16 v[112:115], v[64:67], v[132:135], v[112:115]
    v_mfma_f32_16x16x32_bf16 v[116:119], v[60:63], v[136:139], v[116:119]
    v_mfma_f32_16x16x32_bf16 v[120:123], v[64:67], v[136:139], v[120:123]
    buffer_load_dwordx4 v[52:55], v8, s[28:31], s63 offen offset:1024
    s_waitcnt lgkmcnt(0)
    v_mfma_f32_16x16x32_bf16 v[92:95], v[68:71], v[140:143], v[92:95]
    v_add_u32 v4, 0x10000, v4
    v_add_u32 v5, 0x10000, v5
    ds_read_b128 v[124:127], v4 offset:0
    v_mfma_f32_16x16x32_bf16 v[96:99], v[72:75], v[140:143], v[96:99]
    ds_read_b128 v[128:131], v4 offset:1024
    v_mfma_f32_16x16x32_bf16 v[100:103], v[68:71], v[144:147], v[100:103]
    ds_read_b128 v[132:135], v5 offset:0
    buffer_load_dwordx4 v[56:59], v9, s[28:31], s63 offen offset:1024
    s_add_u32 s63, s63, 4096
    s_and_b32 s63, s63, 0xffff
    v_mfma_f32_16x16x32_bf16 v[104:107], v[72:75], v[144:147], v[104:107]
    ds_read_b128 v[136:139], v5 offset:1024
    v_mfma_f32_16x16x32_bf16 v[108:111], v[68:71], v[148:151], v[108:111]
    v_mfma_f32_16x16x32_bf16 v[112:115], v[72:75], v[148:151], v[112:115]
    v_mfma_f32_16x16x32_bf16 v[116:119], v[68:71], v[152:155], v[116:119]
    v_mfma_f32_16x16x32_bf16 v[120:123], v[72:75], v[152:155], v[120:123]
    s_waitcnt vmcnt(8) lgkmcnt(0)
    s_barrier
    v_mfma_f32_16x16x32_bf16 v[92:95], v[12:15], v[124:127], v[92:95]
    v_add_u32 v6, 0x10000, v6
    v_add_u32 v7, 0x10000, v7
    ds_read_b128 v[140:143], v6 offset:0
    v_lshlrev_b32 v76, 16, v156
    v_mfma_f32_16x16x32_bf16 v[96:99], v[16:19], v[124:127], v[96:99]
    ds_read_b128 v[144:147], v6 offset:1024
    buffer_load_dwordx4 v[60:63], v8, s[28:31], s63 offen offset:0
    v_and_b32 v77, s72, v156
    v_mfma_f32_16x16x32_bf16 v[100:103], v[12:15], v[128:131], v[100:103]
    ds_read_b128 v[148:151], v7 offset:0
    v_lshlrev_b32 v78, 16, v157
    v_mfma_f32_16x16x32_bf16 v[104:107], v[16:19], v[128:131], v[104:107]
    ds_read_b128 v[152:155], v7 offset:1024
    v_and_b32 v79, s72, v157
    v_mfma_f32_16x16x32_bf16 v[108:111], v[12:15], v[132:135], v[108:111]
    buffer_load_dwordx4 v[64:67], v9, s[28:31], s63 offen offset:0
    v_lshlrev_b32 v84, 16, v158
    v_mfma_f32_16x16x32_bf16 v[112:115], v[16:19], v[132:135], v[112:115]
    v_and_b32 v85, s72, v158
    v_mfma_f32_16x16x32_bf16 v[116:119], v[12:15], v[136:139], v[116:119]
    v_lshlrev_b32 v86, 16, v159
    v_mfma_f32_16x16x32_bf16 v[120:123], v[16:19], v[136:139], v[120:123]
    buffer_load_dwordx4 v[68:71], v8, s[28:31], s63 offen offset:1024
    v_and_b32 v87, s72, v159
    s_waitcnt lgkmcnt(0)
    v_mfma_f32_16x16x32_bf16 v[92:95], v[20:23], v[140:143], v[92:95]
    v_add_u32 v4, 0xfffe0000, v4
    v_add_u32 v5, 0xfffe0000, v5
    ds_read_b128 v[124:127], v4 offset:0
    v_lshlrev_b32 v80, 16, v160
    v_mfma_f32_16x16x32_bf16 v[96:99], v[24:27], v[140:143], v[96:99]
    ds_read_b128 v[128:131], v4 offset:1024
    v_and_b32 v81, s72, v160
    v_mfma_f32_16x16x32_bf16 v[100:103], v[20:23], v[144:147], v[100:103]
    ds_read_b128 v[132:135], v5 offset:0
    buffer_load_dwordx4 v[72:75], v9, s[28:31], s63 offen offset:1024
    s_add_u32 s63, s63, 4096
    s_and_b32 s63, s63, 0xffff
    v_lshlrev_b32 v82, 16, v161
    v_mfma_f32_16x16x32_bf16 v[104:107], v[24:27], v[144:147], v[104:107]
    ds_read_b128 v[136:139], v5 offset:1024
    v_and_b32 v83, s72, v161
    v_mfma_f32_16x16x32_bf16 v[108:111], v[20:23], v[148:151], v[108:111]
    v_lshlrev_b32 v88, 16, v162
    v_mfma_f32_16x16x32_bf16 v[112:115], v[24:27], v[148:151], v[112:115]
    v_and_b32 v89, s72, v162
    v_mfma_f32_16x16x32_bf16 v[116:119], v[20:23], v[152:155], v[116:119]
    v_lshlrev_b32 v90, 16, v163
    v_mfma_f32_16x16x32_bf16 v[120:123], v[24:27], v[152:155], v[120:123]
    v_and_b32 v91, s72, v163
    s_waitcnt vmcnt(8) lgkmcnt(0)
    s_barrier
    v_mfma_f32_16x16x32_bf16 v[92:95], v[28:31], v[124:127], v[92:95]
    v_add_u32 v6, 0xfffe0000, v6
    v_add_u32 v7, 0xfffe0000, v7
    ds_read_b128 v[140:143], v6 offset:0
    v_pk_mul_f32 v[156:157], v[76:77], v[76:77]
    v_mfma_f32_16x16x32_bf16 v[96:99], v[32:35], v[124:127], v[96:99]
    ds_read_b128 v[144:147], v6 offset:1024
    buffer_load_dwordx4 v[12:15], v8, s[28:31], s63 offen offset:0
    v_pk_mul_f32 v[158:159], v[78:79], v[78:79]
    v_mfma_f32_16x16x32_bf16 v[100:103], v[28:31], v[128:131], v[100:103]
    ds_read_b128 v[148:151], v7 offset:0
    v_pk_mul_f32 v[160:161], v[80:81], v[80:81]
    v_mfma_f32_16x16x32_bf16 v[104:107], v[32:35], v[128:131], v[104:107]
    ds_read_b128 v[152:155], v7 offset:1024
    v_pk_mul_f32 v[162:163], v[82:83], v[82:83]
    v_mfma_f32_16x16x32_bf16 v[108:111], v[28:31], v[132:135], v[108:111]
    buffer_load_dwordx4 v[16:19], v9, s[28:31], s63 offen offset:0
    v_pk_fma_f32 v[156:157], v[156:157], s[76:77], v[10:11]
    v_mfma_f32_16x16x32_bf16 v[112:115], v[32:35], v[132:135], v[112:115]
    v_pk_fma_f32 v[158:159], v[158:159], s[76:77], v[10:11]
    v_mfma_f32_16x16x32_bf16 v[116:119], v[28:31], v[136:139], v[116:119]
    v_pk_fma_f32 v[160:161], v[160:161], s[76:77], v[10:11]
    v_mfma_f32_16x16x32_bf16 v[120:123], v[32:35], v[136:139], v[120:123]
    buffer_load_dwordx4 v[20:23], v8, s[28:31], s63 offen offset:1024
    v_pk_fma_f32 v[162:163], v[162:163], s[76:77], v[10:11]
    s_waitcnt lgkmcnt(0)
    v_mfma_f32_16x16x32_bf16 v[92:95], v[36:39], v[140:143], v[92:95]
    ds_read_b128 v[124:127], v4 offset:16384
    v_pk_mul_f32 v[156:157], v[156:157], v[76:77]
    v_mfma_f32_16x16x32_bf16 v[96:99], v[40:43], v[140:143], v[96:99]
    ds_read_b128 v[128:131], v4 offset:17408
    v_pk_mul_f32 v[158:159], v[158:159], v[78:79]
    v_mfma_f32_16x16x32_bf16 v[100:103], v[36:39], v[144:147], v[100:103]
    ds_read_b128 v[132:135], v5 offset:16384
    buffer_load_dwordx4 v[24:27], v9, s[28:31], s63 offen offset:1024
    s_add_u32 s63, s63, 4096
    s_and_b32 s63, s63, 0xffff
    v_pk_mul_f32 v[160:161], v[160:161], v[80:81]
    v_mfma_f32_16x16x32_bf16 v[104:107], v[40:43], v[144:147], v[104:107]
    ds_read_b128 v[136:139], v5 offset:17408
    v_pk_mul_f32 v[162:163], v[162:163], v[82:83]
    v_mfma_f32_16x16x32_bf16 v[108:111], v[36:39], v[148:151], v[108:111]
    v_exp_f32 v156, v156
    v_mfma_f32_16x16x32_bf16 v[112:115], v[40:43], v[148:151], v[112:115]
    v_exp_f32 v157, v157
    v_mfma_f32_16x16x32_bf16 v[116:119], v[36:39], v[152:155], v[116:119]
    v_exp_f32 v158, v158
    v_mfma_f32_16x16x32_bf16 v[120:123], v[40:43], v[152:155], v[120:123]
    v_exp_f32 v159, v159
    s_waitcnt vmcnt(8) lgkmcnt(0)
    s_barrier
    v_mfma_f32_16x16x32_bf16 v[92:95], v[44:47], v[124:127], v[92:95]
    ds_read_b128 v[140:143], v6 offset:16384
    v_exp_f32 v160, v160
    v_mfma_f32_16x16x32_bf16 v[96:99], v[48:51], v[124:127], v[96:99]
    ds_read_b128 v[144:147], v6 offset:17408
    buffer_load_dwordx4 v[28:31], v8, s[28:31], s63 offen offset:0
    v_exp_f32 v161, v161
    v_mfma_f32_16x16x32_bf16 v[100:103], v[44:47], v[128:131], v[100:103]
    ds_read_b128 v[148:151], v7 offset:16384
    v_exp_f32 v162, v162
    v_mfma_f32_16x16x32_bf16 v[104:107], v[48:51], v[128:131], v[104:107]
    ds_read_b128 v[152:155], v7 offset:17408
    v_exp_f32 v163, v163
    v_mfma_f32_16x16x32_bf16 v[108:111], v[44:47], v[132:135], v[108:111]
    buffer_load_dwordx4 v[32:35], v9, s[28:31], s63 offen offset:0
    v_pk_add_f32 v[156:157], v[156:157], s[74:75]
    v_mfma_f32_16x16x32_bf16 v[112:115], v[48:51], v[132:135], v[112:115]
    v_pk_add_f32 v[158:159], v[158:159], s[74:75]
    v_mfma_f32_16x16x32_bf16 v[116:119], v[44:47], v[136:139], v[116:119]
    v_pk_add_f32 v[160:161], v[160:161], s[74:75]
    v_mfma_f32_16x16x32_bf16 v[120:123], v[48:51], v[136:139], v[120:123]
    buffer_load_dwordx4 v[36:39], v8, s[28:31], s63 offen offset:1024
    v_pk_add_f32 v[162:163], v[162:163], s[74:75]
    s_waitcnt lgkmcnt(0)
    v_mfma_f32_16x16x32_bf16 v[92:95], v[52:55], v[140:143], v[92:95]
    ds_read_b128 v[124:127], v4 offset:32768
    v_rcp_f32 v156, v156
    v_mfma_f32_16x16x32_bf16 v[96:99], v[56:59], v[140:143], v[96:99]
    ds_read_b128 v[128:131], v4 offset:33792
    v_rcp_f32 v157, v157
    v_mfma_f32_16x16x32_bf16 v[100:103], v[52:55], v[144:147], v[100:103]
    ds_read_b128 v[132:135], v5 offset:32768
    buffer_load_dwordx4 v[40:43], v9, s[28:31], s63 offen offset:1024
    s_add_u32 s63, s63, 4096
    s_and_b32 s63, s63, 0xffff
    v_rcp_f32 v158, v158
    v_mfma_f32_16x16x32_bf16 v[104:107], v[56:59], v[144:147], v[104:107]
    ds_read_b128 v[136:139], v5 offset:33792
    v_rcp_f32 v159, v159
    v_mfma_f32_16x16x32_bf16 v[108:111], v[52:55], v[148:151], v[108:111]
    v_rcp_f32 v160, v160
    v_mfma_f32_16x16x32_bf16 v[112:115], v[56:59], v[148:151], v[112:115]
    v_rcp_f32 v161, v161
    v_mfma_f32_16x16x32_bf16 v[116:119], v[52:55], v[152:155], v[116:119]
    v_rcp_f32 v162, v162
    v_mfma_f32_16x16x32_bf16 v[120:123], v[56:59], v[152:155], v[120:123]
    v_rcp_f32 v163, v163
    s_waitcnt vmcnt(8) lgkmcnt(0)
    s_barrier
    v_mfma_f32_16x16x32_bf16 v[92:95], v[60:63], v[124:127], v[92:95]
    ds_read_b128 v[140:143], v6 offset:32768
    v_pk_mul_f32 v[76:77], v[76:77], v[156:157]
    v_mfma_f32_16x16x32_bf16 v[96:99], v[64:67], v[124:127], v[96:99]
    ds_read_b128 v[144:147], v6 offset:33792
    buffer_load_dwordx4 v[44:47], v8, s[28:31], s63 offen offset:0
    v_pk_mul_f32 v[78:79], v[78:79], v[158:159]
    v_mfma_f32_16x16x32_bf16 v[100:103], v[60:63], v[128:131], v[100:103]
    ds_read_b128 v[148:151], v7 offset:32768
    v_pk_mul_f32 v[80:81], v[80:81], v[160:161]
    v_mfma_f32_16x16x32_bf16 v[104:107], v[64:67], v[128:131], v[104:107]
    ds_read_b128 v[152:155], v7 offset:33792
    v_pk_mul_f32 v[82:83], v[82:83], v[162:163]
    v_mfma_f32_16x16x32_bf16 v[108:111], v[60:63], v[132:135], v[108:111]
    buffer_load_dwordx4 v[48:51], v9, s[28:31], s63 offen offset:0
    v_pk_mul_f32 v[156:157], v[84:85], v[84:85]
    v_mfma_f32_16x16x32_bf16 v[112:115], v[64:67], v[132:135], v[112:115]
    v_pk_mul_f32 v[158:159], v[86:87], v[86:87]
    v_mfma_f32_16x16x32_bf16 v[116:119], v[60:63], v[136:139], v[116:119]
    v_pk_mul_f32 v[160:161], v[88:89], v[88:89]
    v_mfma_f32_16x16x32_bf16 v[120:123], v[64:67], v[136:139], v[120:123]
    buffer_load_dwordx4 v[52:55], v8, s[28:31], s63 offen offset:1024
    v_pk_mul_f32 v[162:163], v[90:91], v[90:91]
    s_waitcnt lgkmcnt(0)
    v_mfma_f32_16x16x32_bf16 v[92:95], v[68:71], v[140:143], v[92:95]
    ds_read_b128 v[124:127], v4 offset:49152
    v_pk_fma_f32 v[156:157], v[156:157], s[76:77], v[10:11]
    v_mfma_f32_16x16x32_bf16 v[96:99], v[72:75], v[140:143], v[96:99]
    ds_read_b128 v[128:131], v4 offset:50176
    v_pk_fma_f32 v[158:159], v[158:159], s[76:77], v[10:11]
    v_mfma_f32_16x16x32_bf16 v[100:103], v[68:71], v[144:147], v[100:103]
    ds_read_b128 v[132:135], v5 offset:49152
    buffer_load_dwordx4 v[56:59], v9, s[28:31], s63 offen offset:1024
    s_add_u32 s63, s63, 4096
    s_and_b32 s63, s63, 0xffff
    v_pk_fma_f32 v[160:161], v[160:161], s[76:77], v[10:11]
    v_mfma_f32_16x16x32_bf16 v[104:107], v[72:75], v[144:147], v[104:107]
    ds_read_b128 v[136:139], v5 offset:50176
    v_pk_fma_f32 v[162:163], v[162:163], s[76:77], v[10:11]
    v_mfma_f32_16x16x32_bf16 v[108:111], v[68:71], v[148:151], v[108:111]
    v_pk_mul_f32 v[156:157], v[156:157], v[84:85]
    v_mfma_f32_16x16x32_bf16 v[112:115], v[72:75], v[148:151], v[112:115]
    v_pk_mul_f32 v[158:159], v[158:159], v[86:87]
    v_mfma_f32_16x16x32_bf16 v[116:119], v[68:71], v[152:155], v[116:119]
    v_pk_mul_f32 v[160:161], v[160:161], v[88:89]
    v_mfma_f32_16x16x32_bf16 v[120:123], v[72:75], v[152:155], v[120:123]
    v_pk_mul_f32 v[162:163], v[162:163], v[90:91]
    s_waitcnt vmcnt(8) lgkmcnt(0)
    s_barrier
    v_mfma_f32_16x16x32_bf16 v[92:95], v[12:15], v[124:127], v[92:95]
    ds_read_b128 v[140:143], v6 offset:49152
    v_exp_f32 v156, v156
    v_mfma_f32_16x16x32_bf16 v[96:99], v[16:19], v[124:127], v[96:99]
    ds_read_b128 v[144:147], v6 offset:50176
    buffer_load_dwordx4 v[60:63], v8, s[28:31], s63 offen offset:0
    v_exp_f32 v157, v157
    v_mfma_f32_16x16x32_bf16 v[100:103], v[12:15], v[128:131], v[100:103]
    ds_read_b128 v[148:151], v7 offset:49152
    v_exp_f32 v158, v158
    v_mfma_f32_16x16x32_bf16 v[104:107], v[16:19], v[128:131], v[104:107]
    ds_read_b128 v[152:155], v7 offset:50176
    v_exp_f32 v159, v159
    v_mfma_f32_16x16x32_bf16 v[108:111], v[12:15], v[132:135], v[108:111]
    buffer_load_dwordx4 v[64:67], v9, s[28:31], s63 offen offset:0
    v_exp_f32 v160, v160
    v_mfma_f32_16x16x32_bf16 v[112:115], v[16:19], v[132:135], v[112:115]
    v_exp_f32 v161, v161
    v_mfma_f32_16x16x32_bf16 v[116:119], v[12:15], v[136:139], v[116:119]
    v_exp_f32 v162, v162
    v_mfma_f32_16x16x32_bf16 v[120:123], v[16:19], v[136:139], v[120:123]
    buffer_load_dwordx4 v[68:71], v8, s[28:31], s63 offen offset:1024
    v_exp_f32 v163, v163
    s_waitcnt lgkmcnt(0)
    v_mfma_f32_16x16x32_bf16 v[92:95], v[20:23], v[140:143], v[92:95]
    v_add_u32 v4, 0x10000, v4
    v_add_u32 v5, 0x10000, v5
    ds_read_b128 v[124:127], v4 offset:0
    v_pk_add_f32 v[156:157], v[156:157], s[74:75]
    v_mfma_f32_16x16x32_bf16 v[96:99], v[24:27], v[140:143], v[96:99]
    ds_read_b128 v[128:131], v4 offset:1024
    v_pk_add_f32 v[158:159], v[158:159], s[74:75]
    v_mfma_f32_16x16x32_bf16 v[100:103], v[20:23], v[144:147], v[100:103]
    ds_read_b128 v[132:135], v5 offset:0
    buffer_load_dwordx4 v[72:75], v9, s[28:31], s63 offen offset:1024
    s_add_u32 s63, s63, 4096
    s_and_b32 s63, s63, 0xffff
    v_pk_add_f32 v[160:161], v[160:161], s[74:75]
    v_mfma_f32_16x16x32_bf16 v[104:107], v[24:27], v[144:147], v[104:107]
    ds_read_b128 v[136:139], v5 offset:1024
    v_pk_add_f32 v[162:163], v[162:163], s[74:75]
    v_mfma_f32_16x16x32_bf16 v[108:111], v[20:23], v[148:151], v[108:111]
    v_rcp_f32 v156, v156
    v_mfma_f32_16x16x32_bf16 v[112:115], v[24:27], v[148:151], v[112:115]
    v_rcp_f32 v157, v157
    v_mfma_f32_16x16x32_bf16 v[116:119], v[20:23], v[152:155], v[116:119]
    v_rcp_f32 v158, v158
    v_mfma_f32_16x16x32_bf16 v[120:123], v[24:27], v[152:155], v[120:123]
    v_rcp_f32 v159, v159
    s_waitcnt vmcnt(8) lgkmcnt(0)
    s_barrier
    v_mfma_f32_16x16x32_bf16 v[92:95], v[28:31], v[124:127], v[92:95]
    v_add_u32 v6, 0x10000, v6
    v_add_u32 v7, 0x10000, v7
    ds_read_b128 v[140:143], v6 offset:0
    v_rcp_f32 v160, v160
    v_mfma_f32_16x16x32_bf16 v[96:99], v[32:35], v[124:127], v[96:99]
    ds_read_b128 v[144:147], v6 offset:1024
    buffer_load_dwordx4 v[12:15], v8, s[28:31], s63 offen offset:0
    v_rcp_f32 v161, v161
    v_mfma_f32_16x16x32_bf16 v[100:103], v[28:31], v[128:131], v[100:103]
    ds_read_b128 v[148:151], v7 offset:0
    v_rcp_f32 v162, v162
    v_mfma_f32_16x16x32_bf16 v[104:107], v[32:35], v[128:131], v[104:107]
    ds_read_b128 v[152:155], v7 offset:1024
    v_rcp_f32 v163, v163
    v_mfma_f32_16x16x32_bf16 v[108:111], v[28:31], v[132:135], v[108:111]
    buffer_load_dwordx4 v[16:19], v9, s[28:31], s63 offen offset:0
    v_pk_mul_f32 v[84:85], v[84:85], v[156:157]
    v_mfma_f32_16x16x32_bf16 v[112:115], v[32:35], v[132:135], v[112:115]
    v_pk_mul_f32 v[86:87], v[86:87], v[158:159]
    v_mfma_f32_16x16x32_bf16 v[116:119], v[28:31], v[136:139], v[116:119]
    v_pk_mul_f32 v[88:89], v[88:89], v[160:161]
    v_mfma_f32_16x16x32_bf16 v[120:123], v[32:35], v[136:139], v[120:123]
    buffer_load_dwordx4 v[20:23], v8, s[28:31], s63 offen offset:1024
    v_pk_mul_f32 v[90:91], v[90:91], v[162:163]
    s_waitcnt lgkmcnt(0)
    v_mfma_f32_16x16x32_bf16 v[92:95], v[36:39], v[140:143], v[92:95]
    ds_read_b128 v[124:127], v4 offset:16384
    v_lshlrev_b32 v156, 16, v164
    v_mfma_f32_16x16x32_bf16 v[96:99], v[40:43], v[140:143], v[96:99]
    ds_read_b128 v[128:131], v4 offset:17408
    v_lshlrev_b32 v157, 16, v164
    v_mfma_f32_16x16x32_bf16 v[100:103], v[36:39], v[144:147], v[100:103]
    ds_read_b128 v[132:135], v5 offset:16384
    buffer_load_dwordx4 v[24:27], v9, s[28:31], s63 offen offset:1024
    s_add_u32 s63, s63, 4096
    s_and_b32 s63, s63, 0xffff
    v_lshlrev_b32 v158, 16, v165
    v_mfma_f32_16x16x32_bf16 v[104:107], v[40:43], v[144:147], v[104:107]
    ds_read_b128 v[136:139], v5 offset:17408
    v_lshlrev_b32 v159, 16, v165
    v_mfma_f32_16x16x32_bf16 v[108:111], v[36:39], v[148:151], v[108:111]
    v_mfma_f32_16x16x32_bf16 v[112:115], v[40:43], v[148:151], v[112:115]
    v_mfma_f32_16x16x32_bf16 v[116:119], v[36:39], v[152:155], v[116:119]
    v_mfma_f32_16x16x32_bf16 v[120:123], v[40:43], v[152:155], v[120:123]
    s_waitcnt vmcnt(8) lgkmcnt(0)
    s_barrier
    v_mfma_f32_16x16x32_bf16 v[92:95], v[44:47], v[124:127], v[92:95]
    ds_read_b128 v[140:143], v6 offset:16384
    v_mfma_f32_16x16x32_bf16 v[96:99], v[48:51], v[124:127], v[96:99]
    ds_read_b128 v[144:147], v6 offset:17408
    buffer_load_dwordx4 v[28:31], v8, s[28:31], s63 offen offset:0
    v_mfma_f32_16x16x32_bf16 v[100:103], v[44:47], v[128:131], v[100:103]
    ds_read_b128 v[148:151], v7 offset:16384
    v_mfma_f32_16x16x32_bf16 v[104:107], v[48:51], v[128:131], v[104:107]
    ds_read_b128 v[152:155], v7 offset:17408
    v_mfma_f32_16x16x32_bf16 v[108:111], v[44:47], v[132:135], v[108:111]
    buffer_load_dwordx4 v[32:35], v9, s[28:31], s63 offen offset:0
    v_mfma_f32_16x16x32_bf16 v[112:115], v[48:51], v[132:135], v[112:115]
    v_mfma_f32_16x16x32_bf16 v[116:119], v[44:47], v[136:139], v[116:119]
    v_mfma_f32_16x16x32_bf16 v[120:123], v[48:51], v[136:139], v[120:123]
    buffer_load_dwordx4 v[36:39], v8, s[28:31], s63 offen offset:1024
    s_waitcnt lgkmcnt(0)
    v_mfma_f32_16x16x32_bf16 v[92:95], v[52:55], v[140:143], v[92:95]
    ds_read_b128 v[124:127], v4 offset:32768
    v_mfma_f32_16x16x32_bf16 v[96:99], v[56:59], v[140:143], v[96:99]
    ds_read_b128 v[128:131], v4 offset:33792
    v_mfma_f32_16x16x32_bf16 v[100:103], v[52:55], v[144:147], v[100:103]
    ds_read_b128 v[132:135], v5 offset:32768
    buffer_load_dwordx4 v[40:43], v9, s[28:31], s63 offen offset:1024
    s_add_u32 s63, s63, 4096
    s_and_b32 s63, s63, 0xffff
    v_mfma_f32_16x16x32_bf16 v[104:107], v[56:59], v[144:147], v[104:107]
    ds_read_b128 v[136:139], v5 offset:33792
    v_mfma_f32_16x16x32_bf16 v[108:111], v[52:55], v[148:151], v[108:111]
    v_mfma_f32_16x16x32_bf16 v[112:115], v[56:59], v[148:151], v[112:115]
    v_mfma_f32_16x16x32_bf16 v[116:119], v[52:55], v[152:155], v[116:119]
    v_mfma_f32_16x16x32_bf16 v[120:123], v[56:59], v[152:155], v[120:123]
    s_waitcnt vmcnt(8) lgkmcnt(0)
    s_barrier
    v_mfma_f32_16x16x32_bf16 v[92:95], v[60:63], v[124:127], v[92:95]
    ds_read_b128 v[140:143], v6 offset:32768
    v_mfma_f32_16x16x32_bf16 v[96:99], v[64:67], v[124:127], v[96:99]
    ds_read_b128 v[144:147], v6 offset:33792
    buffer_load_dwordx4 v[44:47], v8, s[28:31], s63 offen offset:0
    v_mfma_f32_16x16x32_bf16 v[100:103], v[60:63], v[128:131], v[100:103]
    ds_read_b128 v[148:151], v7 offset:32768
    v_mfma_f32_16x16x32_bf16 v[104:107], v[64:67], v[128:131], v[104:107]
    ds_read_b128 v[152:155], v7 offset:33792
    v_mfma_f32_16x16x32_bf16 v[108:111], v[60:63], v[132:135], v[108:111]
    buffer_load_dwordx4 v[48:51], v9, s[28:31], s63 offen offset:0
    v_mfma_f32_16x16x32_bf16 v[112:115], v[64:67], v[132:135], v[112:115]
    v_mfma_f32_16x16x32_bf16 v[116:119], v[60:63], v[136:139], v[116:119]
    v_mfma_f32_16x16x32_bf16 v[120:123], v[64:67], v[136:139], v[120:123]
    buffer_load_dwordx4 v[52:55], v8, s[28:31], s63 offen offset:1024
    s_waitcnt lgkmcnt(0)
    v_mfma_f32_16x16x32_bf16 v[92:95], v[68:71], v[140:143], v[92:95]
    ds_read_b128 v[124:127], v4 offset:49152
    v_mfma_f32_16x16x32_bf16 v[96:99], v[72:75], v[140:143], v[96:99]
    ds_read_b128 v[128:131], v4 offset:50176
    v_mfma_f32_16x16x32_bf16 v[100:103], v[68:71], v[144:147], v[100:103]
    ds_read_b128 v[132:135], v5 offset:49152
    buffer_load_dwordx4 v[56:59], v9, s[28:31], s63 offen offset:1024
    s_add_u32 s63, s63, 4096
    s_and_b32 s63, s63, 0xffff
    v_mfma_f32_16x16x32_bf16 v[104:107], v[72:75], v[144:147], v[104:107]
    ds_read_b128 v[136:139], v5 offset:50176
    v_mfma_f32_16x16x32_bf16 v[108:111], v[68:71], v[148:151], v[108:111]
    v_mfma_f32_16x16x32_bf16 v[112:115], v[72:75], v[148:151], v[112:115]
    v_mfma_f32_16x16x32_bf16 v[116:119], v[68:71], v[152:155], v[116:119]
    v_mfma_f32_16x16x32_bf16 v[120:123], v[72:75], v[152:155], v[120:123]
    s_waitcnt vmcnt(8) lgkmcnt(0)
    s_barrier
    v_mfma_f32_16x16x32_bf16 v[92:95], v[12:15], v[124:127], v[92:95]
    ds_read_b128 v[140:143], v6 offset:49152
    v_mfma_f32_16x16x32_bf16 v[96:99], v[16:19], v[124:127], v[96:99]
    ds_read_b128 v[144:147], v6 offset:50176
    buffer_load_dwordx4 v[60:63], v8, s[28:31], s63 offen offset:0
    v_mfma_f32_16x16x32_bf16 v[100:103], v[12:15], v[128:131], v[100:103]
    ds_read_b128 v[148:151], v7 offset:49152
    v_mfma_f32_16x16x32_bf16 v[104:107], v[16:19], v[128:131], v[104:107]
    ds_read_b128 v[152:155], v7 offset:50176
    v_mfma_f32_16x16x32_bf16 v[108:111], v[12:15], v[132:135], v[108:111]
    buffer_load_dwordx4 v[64:67], v9, s[28:31], s63 offen offset:0
    v_mfma_f32_16x16x32_bf16 v[112:115], v[16:19], v[132:135], v[112:115]
    v_mfma_f32_16x16x32_bf16 v[116:119], v[12:15], v[136:139], v[116:119]
    v_mfma_f32_16x16x32_bf16 v[120:123], v[16:19], v[136:139], v[120:123]
    buffer_load_dwordx4 v[68:71], v8, s[28:31], s63 offen offset:1024
    s_waitcnt lgkmcnt(0)
    v_mfma_f32_16x16x32_bf16 v[92:95], v[20:23], v[140:143], v[92:95]
    v_add_u32 v4, 0x10000, v4
    v_add_u32 v5, 0x10000, v5
    ds_read_b128 v[124:127], v4 offset:0
    v_mfma_f32_16x16x32_bf16 v[96:99], v[24:27], v[140:143], v[96:99]
    ds_read_b128 v[128:131], v4 offset:1024
    v_mfma_f32_16x16x32_bf16 v[100:103], v[20:23], v[144:147], v[100:103]
    ds_read_b128 v[132:135], v5 offset:0
    buffer_load_dwordx4 v[72:75], v9, s[28:31], s63 offen offset:1024
    s_add_u32 s63, s63, 4096
    s_and_b32 s63, s63, 0xffff
    v_mfma_f32_16x16x32_bf16 v[104:107], v[24:27], v[144:147], v[104:107]
    ds_read_b128 v[136:139], v5 offset:1024
    v_mfma_f32_16x16x32_bf16 v[108:111], v[20:23], v[148:151], v[108:111]
    v_mfma_f32_16x16x32_bf16 v[112:115], v[24:27], v[148:151], v[112:115]
    v_mfma_f32_16x16x32_bf16 v[116:119], v[20:23], v[152:155], v[116:119]
    v_mfma_f32_16x16x32_bf16 v[120:123], v[24:27], v[152:155], v[120:123]
    s_waitcnt vmcnt(8) lgkmcnt(0)
    s_barrier
    v_mfma_f32_16x16x32_bf16 v[92:95], v[28:31], v[124:127], v[92:95]
    v_add_u32 v6, 0x10000, v6
    v_add_u32 v7, 0x10000, v7
    ds_read_b128 v[140:143], v6 offset:0
    v_mfma_f32_16x16x32_bf16 v[96:99], v[32:35], v[124:127], v[96:99]
    ds_read_b128 v[144:147], v6 offset:1024
    v_mfma_f32_16x16x32_bf16 v[100:103], v[28:31], v[128:131], v[100:103]
    ds_read_b128 v[148:151], v7 offset:0
    v_mfma_f32_16x16x32_bf16 v[104:107], v[32:35], v[128:131], v[104:107]
    ds_read_b128 v[152:155], v7 offset:1024
    v_mfma_f32_16x16x32_bf16 v[108:111], v[28:31], v[132:135], v[108:111]
    v_mfma_f32_16x16x32_bf16 v[112:115], v[32:35], v[132:135], v[112:115]
    v_mfma_f32_16x16x32_bf16 v[116:119], v[28:31], v[136:139], v[116:119]
    v_mfma_f32_16x16x32_bf16 v[120:123], v[32:35], v[136:139], v[120:123]
    s_waitcnt lgkmcnt(0)
    v_mfma_f32_16x16x32_bf16 v[92:95], v[36:39], v[140:143], v[92:95]
    v_add_u32 v4, 0xffff0000, v4
    v_add_u32 v5, 0xffff0000, v5
    ds_read_b128 v[124:127], v4 offset:0
    v_mfma_f32_16x16x32_bf16 v[96:99], v[40:43], v[140:143], v[96:99]
    ds_read_b128 v[128:131], v4 offset:1024
    v_mfma_f32_16x16x32_bf16 v[100:103], v[36:39], v[144:147], v[100:103]
    ds_read_b128 v[132:135], v5 offset:0
    v_mfma_f32_16x16x32_bf16 v[104:107], v[40:43], v[144:147], v[104:107]
    ds_read_b128 v[136:139], v5 offset:1024
    v_mfma_f32_16x16x32_bf16 v[108:111], v[36:39], v[148:151], v[108:111]
    v_mfma_f32_16x16x32_bf16 v[112:115], v[40:43], v[148:151], v[112:115]
    v_mfma_f32_16x16x32_bf16 v[116:119], v[36:39], v[152:155], v[116:119]
    v_mfma_f32_16x16x32_bf16 v[120:123], v[40:43], v[152:155], v[120:123]
    s_waitcnt vmcnt(4) lgkmcnt(0)
    s_barrier
    v_mfma_f32_16x16x32_bf16 v[92:95], v[44:47], v[124:127], v[92:95]
    v_add_u32 v6, 0xffff0000, v6
    v_add_u32 v7, 0xffff0000, v7
    ds_read_b128 v[140:143], v6 offset:0
    buffer_load_dwordx4 v[12:15], v1, s[44:47], s66 offen offset:0
    v_mfma_f32_16x16x32_bf16 v[96:99], v[48:51], v[124:127], v[96:99]
    ds_read_b128 v[144:147], v6 offset:1024
    buffer_load_dwordx4 v[16:19], v1, s[44:47], s66 offen offset:2048
    s_add_u32 s66, s66, 4096
    v_mfma_f32_16x16x32_bf16 v[100:103], v[44:47], v[128:131], v[100:103]
    ds_read_b128 v[148:151], v7 offset:0
    buffer_load_dwordx4 v[20:23], v1, s[44:47], s66 offen offset:0
    v_mfma_f32_16x16x32_bf16 v[104:107], v[48:51], v[128:131], v[104:107]
    ds_read_b128 v[152:155], v7 offset:1024
    buffer_load_dwordx4 v[24:27], v1, s[44:47], s66 offen offset:2048
    s_add_u32 s66, s66, 4096
    v_mfma_f32_16x16x32_bf16 v[108:111], v[44:47], v[132:135], v[108:111]
    buffer_load_dwordx4 v[28:31], v1, s[44:47], s66 offen offset:0
    v_mfma_f32_16x16x32_bf16 v[112:115], v[48:51], v[132:135], v[112:115]
    v_mfma_f32_16x16x32_bf16 v[116:119], v[44:47], v[136:139], v[116:119]
    v_mfma_f32_16x16x32_bf16 v[120:123], v[48:51], v[136:139], v[120:123]
    buffer_load_dwordx4 v[32:35], v1, s[44:47], s66 offen offset:2048
    s_add_u32 s66, s66, 4096
    s_waitcnt lgkmcnt(0)
    v_mfma_f32_16x16x32_bf16 v[92:95], v[52:55], v[140:143], v[92:95]
    ds_read_b128 v[124:127], v4 offset:16384
    v_mfma_f32_16x16x32_bf16 v[96:99], v[56:59], v[140:143], v[96:99]
    ds_read_b128 v[128:131], v4 offset:17408
    v_mfma_f32_16x16x32_bf16 v[100:103], v[52:55], v[144:147], v[100:103]
    ds_read_b128 v[132:135], v5 offset:16384
    buffer_load_dwordx4 v[36:39], v1, s[44:47], s66 offen offset:0
    v_mfma_f32_16x16x32_bf16 v[104:107], v[56:59], v[144:147], v[104:107]
    ds_read_b128 v[136:139], v5 offset:17408
    v_mfma_f32_16x16x32_bf16 v[108:111], v[52:55], v[148:151], v[108:111]
    v_mfma_f32_16x16x32_bf16 v[112:115], v[56:59], v[148:151], v[112:115]
    buffer_load_dwordx4 v[40:43], v1, s[44:47], s66 offen offset:2048
    s_add_u32 s66, s66, 4096
    v_mfma_f32_16x16x32_bf16 v[116:119], v[52:55], v[152:155], v[116:119]
    v_mfma_f32_16x16x32_bf16 v[120:123], v[56:59], v[152:155], v[120:123]
    s_waitcnt vmcnt(8) lgkmcnt(0)
    v_mfma_f32_16x16x32_bf16 v[92:95], v[60:63], v[124:127], v[92:95]
    ds_read_b128 v[140:143], v6 offset:16384
    v_mfma_f32_16x16x32_bf16 v[96:99], v[64:67], v[124:127], v[96:99]
    ds_read_b128 v[144:147], v6 offset:17408
    buffer_load_dwordx4 v[44:47], v1, s[44:47], s66 offen offset:0
    v_mfma_f32_16x16x32_bf16 v[100:103], v[60:63], v[128:131], v[100:103]
    ds_read_b128 v[148:151], v7 offset:16384
    v_mfma_f32_16x16x32_bf16 v[104:107], v[64:67], v[128:131], v[104:107]
    ds_read_b128 v[152:155], v7 offset:17408
    v_mfma_f32_16x16x32_bf16 v[108:111], v[60:63], v[132:135], v[108:111]
    buffer_load_dwordx4 v[48:51], v1, s[44:47], s66 offen offset:2048
    s_add_u32 s66, s66, 4096
    v_mfma_f32_16x16x32_bf16 v[112:115], v[64:67], v[132:135], v[112:115]
    v_mfma_f32_16x16x32_bf16 v[116:119], v[60:63], v[136:139], v[116:119]
    v_mfma_f32_16x16x32_bf16 v[120:123], v[64:67], v[136:139], v[120:123]
    s_waitcnt lgkmcnt(0)
    v_mfma_f32_16x16x32_bf16 v[92:95], v[68:71], v[140:143], v[92:95]
    v_mfma_f32_16x16x32_bf16 v[96:99], v[72:75], v[140:143], v[96:99]
    v_mfma_f32_16x16x32_bf16 v[100:103], v[68:71], v[144:147], v[100:103]
    v_mfma_f32_16x16x32_bf16 v[104:107], v[72:75], v[144:147], v[104:107]
    v_mfma_f32_16x16x32_bf16 v[108:111], v[68:71], v[148:151], v[108:111]
    v_mfma_f32_16x16x32_bf16 v[112:115], v[72:75], v[148:151], v[112:115]
    v_mfma_f32_16x16x32_bf16 v[116:119], v[68:71], v[152:155], v[116:119]
    v_mfma_f32_16x16x32_bf16 v[120:123], v[72:75], v[152:155], v[120:123]
    s_lshl_b32 s57, s52, 12
    s_add_u32 s57, s57, 98304
    v_add_u32 v3, s57, v1
    s_xor_b32 s57, s52, 4
    s_lshl_b32 s57, s57, 12
    s_add_u32 s57, s57, 98304
    v_add_u32 v10, s57, v1
    ds_write_b128 v3, v[108:111] offset:0
    ds_write_b128 v3, v[112:115] offset:1024
    ds_write_b128 v3, v[116:119] offset:2048
    ds_write_b128 v3, v[120:123] offset:3072
    s_lshl_b32 s58, s55, 1
    s_add_u32 s58, s58, s54
    s_mul_i32 s58, s58, 94
    s_lshl_b32 s57, s56, 2
    s_add_u32 s57, s57, s53
    s_add_u32 s58, s58, s57
    s_add_u32 s58, s58, 20
    s_lshl_b32 s58, s58, 10
    s_add_u32 s59, s58, 48128
    s_cmp_ge_u32 s57, 27
    s_cselect_b32 s58, s46, s58
    s_cselect_b32 s59, s46, s59
    v_pk_add_f32 v[92:93], v[92:93], v[156:157]
    v_pk_add_f32 v[94:95], v[94:95], v[156:157]
    v_pk_add_f32 v[96:97], v[96:97], v[156:157]
    v_pk_add_f32 v[98:99], v[98:99], v[156:157]
    v_pk_add_f32 v[100:101], v[100:101], v[158:159]
    v_pk_add_f32 v[102:103], v[102:103], v[158:159]
    v_pk_add_f32 v[104:105], v[104:105], v[158:159]
    v_pk_add_f32 v[106:107], v[106:107], v[158:159]
    s_waitcnt lgkmcnt(0)
    s_barrier
    ds_read_b128 v[124:127], v10 offset:0
    ds_read_b128 v[128:131], v10 offset:1024
    ds_read_b128 v[132:135], v10 offset:2048
    ds_read_b128 v[136:139], v10 offset:3072
    s_waitcnt lgkmcnt(2)
    v_pk_add_f32 v[92:93], v[92:93], v[124:125]
    v_pk_add_f32 v[94:95], v[94:95], v[126:127]
    v_pk_add_f32 v[96:97], v[96:97], v[128:129]
    v_pk_add_f32 v[98:99], v[98:99], v[130:131]
    v_pk_mul_f32 v[92:93], v[92:93], v[76:77]
    v_pk_mul_f32 v[94:95], v[94:95], v[78:79]
    v_pk_mul_f32 v[96:97], v[96:97], v[80:81]
    v_pk_mul_f32 v[98:99], v[98:99], v[82:83]
    v_cvt_pk_bf16_f32 v156, v92, v93
    v_cvt_pk_bf16_f32 v157, v94, v95
    v_cvt_pk_bf16_f32 v158, v96, v97
    v_cvt_pk_bf16_f32 v159, v98, v99
    buffer_store_dwordx4 v[156:159], v1, s[44:47], s58 offen sc1
    s_waitcnt lgkmcnt(0)
    v_pk_add_f32 v[100:101], v[100:101], v[132:133]
    v_pk_add_f32 v[102:103], v[102:103], v[134:135]
    v_pk_add_f32 v[104:105], v[104:105], v[136:137]
    v_pk_add_f32 v[106:107], v[106:107], v[138:139]
    v_pk_mul_f32 v[100:101], v[100:101], v[84:85]
    v_pk_mul_f32 v[102:103], v[102:103], v[86:87]
    v_pk_mul_f32 v[104:105], v[104:105], v[88:89]
    v_pk_mul_f32 v[106:107], v[106:107], v[90:91]
    v_cvt_pk_bf16_f32 v160, v100, v101
    v_cvt_pk_bf16_f32 v161, v102, v103
    v_cvt_pk_bf16_f32 v162, v104, v105
    v_cvt_pk_bf16_f32 v163, v106, v107
    buffer_store_dwordx4 v[160:163], v1, s[44:47], s59 offen sc1
k3comp_94:
    v_bfe_u32 v3, v0, 2, 2
    v_and_b32 v152, 3, v0
    v_lshl_add_u32 v3, v3, 3, v152
    s_lshl_b32 s57, s55, 6
    s_lshr_b32 s58, s53, 1
    s_lshl_b32 s58, s58, 5
    s_add_u32 s57, s57, s58
    s_and_b32 s58, s53, 1
    s_lshl_b32 s58, s58, 2
    s_add_u32 s57, s57, s58
    v_add_u32 v3, s57, v3
    v_mul_u32_u24 v3, 1280, v3
    s_mul_i32 s57, s56, 160
    v_add_u32 v3, s57, v3
    v_bfe_u32 v152, v0, 4, 2
    v_lshl_add_u32 v8, v152, 4, v3
    v_lshl_add_u32 v9, v152, 3, v3
    s_mul_i32 s57, s54, 5120
    v_add_u32 v4, s57, v1
    v_add_u32 v5, 65536, v4
    v_add_u32 v6, 126976, v4
    v_mov_b32 v10, 1
    s_mov_b32 s28, s4
    s_mov_b32 s29, s5
    s_mov_b32 s30, 0x280000
    s_mov_b32 s31, 0x20000
    s_mov_b32 s40, s20
    s_mov_b32 s41, s21
    s_mov_b32 s42, 0x280000
    s_mov_b32 s43, 0x20000
    s_barrier
    ds_read_b128 v[92:95], v4 offset:0
    ds_read_b128 v[96:99], v4 offset:1024
    ds_read_b128 v[100:103], v4 offset:2048
    ds_read_b128 v[104:107], v4 offset:3072
    ds_read_b128 v[108:111], v4 offset:4096
    s_waitcnt vmcnt(2)
    s_waitcnt lgkmcnt(0)
    v_mfma_f32_16x16x32_bf16 v[132:135], v[92:95], v[12:15], 0
    ds_read_b128 v[112:115], v4 offset:10240
    v_mfma_f32_16x16x32_bf16 v[136:139], v[96:99], v[12:15], 0
    ds_read_b128 v[116:119], v4 offset:11264
    v_mfma_f32_16x16x32_bf16 v[140:143], v[100:103], v[12:15], 0
    ds_read_b128 v[120:123], v4 offset:12288
    v_mfma_f32_16x16x32_bf16 v[144:147], v[104:107], v[12:15], 0
    ds_read_b128 v[124:127], v4 offset:13312
    v_mfma_f32_16x16x32_bf16 v[148:151], v[108:111], v[12:15], 0
    ds_read_b128 v[128:131], v4 offset:14336
    s_waitcnt lgkmcnt(0)
    v_mfma_f32_16x16x32_bf16 v[132:135], v[112:115], v[16:19], v[132:135]
    ds_read_b128 v[92:95], v4 offset:20480
    v_mfma_f32_16x16x32_bf16 v[136:139], v[116:119], v[16:19], v[136:139]
    ds_read_b128 v[96:99], v4 offset:21504
    v_mfma_f32_16x16x32_bf16 v[140:143], v[120:123], v[16:19], v[140:143]
    ds_read_b128 v[100:103], v4 offset:22528
    v_mfma_f32_16x16x32_bf16 v[144:147], v[124:127], v[16:19], v[144:147]
    ds_read_b128 v[104:107], v4 offset:23552
    v_mfma_f32_16x16x32_bf16 v[148:151], v[128:131], v[16:19], v[148:151]
    ds_read_b128 v[108:111], v4 offset:24576
    s_waitcnt lgkmcnt(0)
    v_mfma_f32_16x16x32_bf16 v[132:135], v[92:95], v[20:23], v[132:135]
    ds_read_b128 v[112:115], v4 offset:30720
    v_mfma_f32_16x16x32_bf16 v[136:139], v[96:99], v[20:23], v[136:139]
    ds_read_b128 v[116:119], v4 offset:31744
    v_mfma_f32_16x16x32_bf16 v[140:143], v[100:103], v[20:23], v[140:143]
    ds_read_b128 v[120:123], v4 offset:32768
    v_mfma_f32_16x16x32_bf16 v[144:147], v[104:107], v[20:23], v[144:147]
    ds_read_b128 v[124:127], v4 offset:33792
    v_mfma_f32_16x16x32_bf16 v[148:151], v[108:111], v[20:23], v[148:151]
    ds_read_b128 v[128:131], v4 offset:34816
    s_waitcnt lgkmcnt(0)
    v_mfma_f32_16x16x32_bf16 v[132:135], v[112:115], v[24:27], v[132:135]
    ds_read_b128 v[92:95], v4 offset:40960
    v_mfma_f32_16x16x32_bf16 v[136:139], v[116:119], v[24:27], v[136:139]
    ds_read_b128 v[96:99], v4 offset:41984
    v_mfma_f32_16x16x32_bf16 v[140:143], v[120:123], v[24:27], v[140:143]
    ds_read_b128 v[100:103], v4 offset:43008
    v_mfma_f32_16x16x32_bf16 v[144:147], v[124:127], v[24:27], v[144:147]
    ds_read_b128 v[104:107], v4 offset:44032
    v_mfma_f32_16x16x32_bf16 v[148:151], v[128:131], v[24:27], v[148:151]
    ds_read_b128 v[108:111], v4 offset:45056
    s_waitcnt lgkmcnt(0)
    v_mfma_f32_16x16x32_bf16 v[132:135], v[92:95], v[28:31], v[132:135]
    ds_read_b128 v[112:115], v4 offset:51200
    v_mfma_f32_16x16x32_bf16 v[136:139], v[96:99], v[28:31], v[136:139]
    ds_read_b128 v[116:119], v4 offset:52224
    v_mfma_f32_16x16x32_bf16 v[140:143], v[100:103], v[28:31], v[140:143]
    ds_read_b128 v[120:123], v4 offset:53248
    v_mfma_f32_16x16x32_bf16 v[144:147], v[104:107], v[28:31], v[144:147]
    ds_read_b128 v[124:127], v4 offset:54272
    v_mfma_f32_16x16x32_bf16 v[148:151], v[108:111], v[28:31], v[148:151]
    ds_read_b128 v[128:131], v4 offset:55296
    s_cmp_eq_u32 s56, 7
    s_cbranch_scc1 k3a_104
    v_mov_b32 v3, 150784
    s_mov_b64 exec, 1
    s_waitcnt vmcnt(0)
    ds_add_rtn_u32 v11, v3, v10
    s_waitcnt lgkmcnt(0)
    v_readfirstlane_b32 s57, v11
    s_nop 0
    s_cmp_lg_u32 s57, 7
    s_cbranch_scc1 k3a_104
    buffer_atomic_add v10, v2, s[48:51], s71 offen sc1
k3a_104:
    s_mov_b64 exec, -1
    s_waitcnt lgkmcnt(0)
    s_barrier
    v_mfma_f32_16x16x32_bf16 v[132:135], v[112:115], v[32:35], v[132:135]
    ds_read_b128 v[92:95], v5 offset:0
    v_mfma_f32_16x16x32_bf16 v[136:139], v[116:119], v[32:35], v[136:139]
    ds_read_b128 v[96:99], v5 offset:1024
    v_mfma_f32_16x16x32_bf16 v[140:143], v[120:123], v[32:35], v[140:143]
    ds_read_b128 v[100:103], v5 offset:2048
    v_mfma_f32_16x16x32_bf16 v[144:147], v[124:127], v[32:35], v[144:147]
    ds_read_b128 v[104:107], v5 offset:3072
    v_mfma_f32_16x16x32_bf16 v[148:151], v[128:131], v[32:35], v[148:151]
    ds_read_b128 v[108:111], v5 offset:4096
    s_waitcnt lgkmcnt(0)
    v_mfma_f32_16x16x32_bf16 v[132:135], v[92:95], v[36:39], v[132:135]
    ds_read_b128 v[112:115], v5 offset:10240
    v_mfma_f32_16x16x32_bf16 v[136:139], v[96:99], v[36:39], v[136:139]
    ds_read_b128 v[116:119], v5 offset:11264
    v_mfma_f32_16x16x32_bf16 v[140:143], v[100:103], v[36:39], v[140:143]
    ds_read_b128 v[120:123], v5 offset:12288
    v_mfma_f32_16x16x32_bf16 v[144:147], v[104:107], v[36:39], v[144:147]
    ds_read_b128 v[124:127], v5 offset:13312
    v_mfma_f32_16x16x32_bf16 v[148:151], v[108:111], v[36:39], v[148:151]
    ds_read_b128 v[128:131], v5 offset:14336
    s_waitcnt lgkmcnt(0)
    v_mfma_f32_16x16x32_bf16 v[132:135], v[112:115], v[40:43], v[132:135]
    ds_read_b128 v[92:95], v5 offset:20480
    v_mfma_f32_16x16x32_bf16 v[136:139], v[116:119], v[40:43], v[136:139]
    ds_read_b128 v[96:99], v5 offset:21504
    v_mfma_f32_16x16x32_bf16 v[140:143], v[120:123], v[40:43], v[140:143]
    ds_read_b128 v[100:103], v5 offset:22528
    v_mfma_f32_16x16x32_bf16 v[144:147], v[124:127], v[40:43], v[144:147]
    ds_read_b128 v[104:107], v5 offset:23552
    v_mfma_f32_16x16x32_bf16 v[148:151], v[128:131], v[40:43], v[148:151]
    ds_read_b128 v[108:111], v5 offset:24576
    s_cmp_lg_u32 s52, 0
    s_cbranch_scc1 k3e_105
    buffer_load_dword v152, v2, s[48:51], s71 offen sc1
k3e_105:
    s_waitcnt lgkmcnt(0)
    v_mfma_f32_16x16x32_bf16 v[132:135], v[92:95], v[44:47], v[132:135]
    ds_read_b128 v[112:115], v5 offset:30720
    v_mfma_f32_16x16x32_bf16 v[136:139], v[96:99], v[44:47], v[136:139]
    ds_read_b128 v[116:119], v5 offset:31744
    v_mfma_f32_16x16x32_bf16 v[140:143], v[100:103], v[44:47], v[140:143]
    ds_read_b128 v[120:123], v5 offset:32768
    v_mfma_f32_16x16x32_bf16 v[144:147], v[104:107], v[44:47], v[144:147]
    ds_read_b128 v[124:127], v5 offset:33792
    v_mfma_f32_16x16x32_bf16 v[148:151], v[108:111], v[44:47], v[148:151]
    ds_read_b128 v[128:131], v5 offset:34816
    s_cmp_lg_u32 s52, 0
    s_cbranch_scc1 k3e_106
    buffer_load_dword v153, v2, s[48:51], s71 offen sc1
k3e_106:
    s_waitcnt lgkmcnt(0)
    s_barrier
    v_mfma_f32_16x16x32_bf16 v[132:135], v[112:115], v[48:51], v[132:135]
    ds_read_b128 v[92:95], v5 offset:40960
    v_mfma_f32_16x16x32_bf16 v[136:139], v[116:119], v[48:51], v[136:139]
    ds_read_b128 v[96:99], v5 offset:41984
    v_mfma_f32_16x16x32_bf16 v[140:143], v[120:123], v[48:51], v[140:143]
    ds_read_b128 v[100:103], v5 offset:43008
    v_mfma_f32_16x16x32_bf16 v[144:147], v[124:127], v[48:51], v[144:147]
    ds_read_b128 v[104:107], v5 offset:44032
    v_mfma_f32_16x16x32_bf16 v[148:151], v[128:131], v[48:51], v[148:151]
    ds_read_b128 v[108:111], v5 offset:45056
    s_cmp_lg_u32 s52, 0
    s_cbranch_scc1 k3e_107
    buffer_load_dword v154, v2, s[48:51], s71 offen sc1
k3e_107:
    s_cmp_lg_u32 s52, 0
    s_cbranch_scc1 k3q_108
    s_cmp_lg_u32 s56, 7
    s_cbranch_scc1 k3z_109
    v_mov_b32 v11, 0
    s_mov_b32 s64, 0
sp_111:
    v_readfirstlane_b32 s57, v11
    s_add_u32 s64, s64, 1
    s_cmp_ge_u32 s57, 1
    s_cbranch_scc1 sp_112
    s_cmp_ge_u32 s64, 262144
    s_cbranch_scc1 sp_112
    s_cmp_lg_u32 s57, 0
    s_cbranch_scc1 sp_113
    s_sleep 16
sp_113:
    s_sleep 1
    buffer_load_dword v11, v2, s[48:51], s71 offen sc1
    s_waitcnt vmcnt(0)
    s_branch sp_111
sp_112:
k3z_109:
    s_mov_b32 s64, 0
k3p_110:
    buffer_load_dword v155, v2, s[48:51], s71 offen sc1
    s_waitcnt vmcnt(3)
    v_readfirstlane_b32 s57, v152
    s_nop 0
    s_cmp_ge_u32 s57, 7
    s_cbranch_scc1 k3q_108
    s_sleep 1
    buffer_load_dword v152, v2, s[48:51], s71 offen sc1
    s_waitcnt vmcnt(3)
    v_readfirstlane_b32 s57, v153
    s_nop 0
    s_cmp_ge_u32 s57, 7
    s_cbranch_scc1 k3q_108
    s_sleep 1
    buffer_load_dword v153, v2, s[48:51], s71 offen sc1
    s_waitcnt vmcnt(3)
    v_readfirstlane_b32 s57, v154
    s_nop 0
    s_cmp_ge_u32 s57, 7
    s_cbranch_scc1 k3q_108
    s_sleep 1
    buffer_load_dword v154, v2, s[48:51], s71 offen sc1
    s_waitcnt vmcnt(3)
    v_readfirstlane_b32 s57, v155
    s_nop 0
    s_cmp_ge_u32 s57, 7
    s_cbranch_scc1 k3q_108
    s_sleep 1
    s_add_u32 s64, s64, 1
    s_cmp_lt_u32 s64, 262144
    s_cbranch_scc1 k3p_110
k3q_108:
    s_barrier
    buffer_load_dwordx4 v[52:55], v1, s[44:47], s66 offen offset:0
    buffer_load_dwordx4 v[56:59], v1, s[44:47], s66 offen offset:2048
    s_add_u32 s66, s66, 4096
    buffer_load_dwordx4 v[60:63], v1, s[44:47], s66 offen offset:0
    buffer_load_dwordx4 v[64:67], v1, s[44:47], s66 offen offset:2048
    s_add_u32 s66, s66, 4096
    buffer_load_dwordx4 v[68:71], v1, s[44:47], s66 offen offset:0
    buffer_load_dwordx4 v[72:75], v1, s[44:47], s66 offen offset:2048
    s_add_u32 s66, s66, 4096
    s_waitcnt lgkmcnt(0) vmcnt(5)
    v_mfma_f32_16x16x32_bf16 v[132:135], v[92:95], v[52:55], v[132:135]
    ds_read_b128 v[112:115], v5 offset:51200
    v_mfma_f32_16x16x32_bf16 v[136:139], v[96:99], v[52:55], v[136:139]
    ds_read_b128 v[116:119], v5 offset:52224
    buffer_load_dwordx4 v[12:15], v1, s[44:47], s66 offen offset:0
    v_mfma_f32_16x16x32_bf16 v[140:143], v[100:103], v[52:55], v[140:143]
    ds_read_b128 v[120:123], v5 offset:53248
    v_mfma_f32_16x16x32_bf16 v[144:147], v[104:107], v[52:55], v[144:147]
    ds_read_b128 v[124:127], v5 offset:54272
    buffer_load_dwordx4 v[16:19], v1, s[44:47], s66 offen offset:2048
    s_add_u32 s66, s66, 4096
    v_mfma_f32_16x16x32_bf16 v[148:151], v[108:111], v[52:55], v[148:151]
    ds_read_b128 v[128:131], v5 offset:55296
    s_waitcnt lgkmcnt(0) vmcnt(6)
    v_mfma_f32_16x16x32_bf16 v[132:135], v[112:115], v[56:59], v[132:135]
    ds_read_b128 v[92:95], v6 offset:0
    v_mfma_f32_16x16x32_bf16 v[136:139], v[116:119], v[56:59], v[136:139]
    ds_read_b128 v[96:99], v6 offset:1024
    buffer_load_dwordx4 v[20:23], v1, s[44:47], s66 offen offset:0
    v_mfma_f32_16x16x32_bf16 v[140:143], v[120:123], v[56:59], v[140:143]
    ds_read_b128 v[100:103], v6 offset:2048
    v_mfma_f32_16x16x32_bf16 v[144:147], v[124:127], v[56:59], v[144:147]
    ds_read_b128 v[104:107], v6 offset:3072
    buffer_load_dwordx4 v[24:27], v1, s[44:47], s66 offen offset:2048
    s_add_u32 s66, s66, 4096
    v_mfma_f32_16x16x32_bf16 v[148:151], v[128:131], v[56:59], v[148:151]
    ds_read_b128 v[108:111], v6 offset:4096
    s_waitcnt lgkmcnt(0) vmcnt(7)
    v_mfma_f32_16x16x32_bf16 v[132:135], v[92:95], v[60:63], v[132:135]
    ds_read_b128 v[112:115], v6 offset:10240
    v_mfma_f32_16x16x32_bf16 v[136:139], v[96:99], v[60:63], v[136:139]
    ds_read_b128 v[116:119], v6 offset:11264
    buffer_load_dwordx4 v[28:31], v1, s[44:47], s66 offen offset:0
    v_mfma_f32_16x16x32_bf16 v[140:143], v[100:103], v[60:63], v[140:143]
    ds_read_b128 v[120:123], v6 offset:12288
    v_mfma_f32_16x16x32_bf16 v[144:147], v[104:107], v[60:63], v[144:147]
    ds_read_b128 v[124:127], v6 offset:13312
    buffer_load_dwordx4 v[32:35], v1, s[44:47], s66 offen offset:2048
    s_add_u32 s66, s66, 4096
    v_mfma_f32_16x16x32_bf16 v[148:151], v[108:111], v[60:63], v[148:151]
    ds_read_b128 v[128:131], v6 offset:14336
    s_waitcnt lgkmcnt(0) vmcnt(8)
    v_mfma_f32_16x16x32_bf16 v[132:135], v[112:115], v[64:67], v[132:135]
    ds_read_b128 v[92:95], v4 offset:0
    v_mfma_f32_16x16x32_bf16 v[136:139], v[116:119], v[64:67], v[136:139]
    ds_read_b128 v[96:99], v4 offset:1024
    buffer_load_dwordx4 v[36:39], v1, s[44:47], s66 offen offset:0
    v_mfma_f32_16x16x32_bf16 v[140:143], v[120:123], v[64:67], v[140:143]
    ds_read_b128 v[100:103], v4 offset:2048
    v_mfma_f32_16x16x32_bf16 v[144:147], v[124:127], v[64:67], v[144:147]
    ds_read_b128 v[104:107], v4 offset:3072
    buffer_load_dwordx4 v[40:43], v1, s[44:47], s66 offen offset:2048
    s_add_u32 s66, s66, 4096
    v_mfma_f32_16x16x32_bf16 v[148:151], v[128:131], v[64:67], v[148:151]
    ds_read_b128 v[108:111], v4 offset:4096
    s_waitcnt lgkmcnt(0) vmcnt(9)
    s_barrier
    v_mfma_f32_16x16x32_bf16 v[132:135], v[92:95], v[68:71], v[132:135]
    ds_read_b128 v[112:115], v4 offset:10240
    v_mfma_f32_16x16x32_bf16 v[136:139], v[96:99], v[68:71], v[136:139]
    ds_read_b128 v[116:119], v4 offset:11264
    v_mfma_f32_16x16x32_bf16 v[140:143], v[100:103], v[68:71], v[140:143]
    ds_read_b128 v[120:123], v4 offset:12288
    v_mfma_f32_16x16x32_bf16 v[144:147], v[104:107], v[68:71], v[144:147]
    ds_read_b128 v[124:127], v4 offset:13312
    v_mfma_f32_16x16x32_bf16 v[148:151], v[108:111], v[68:71], v[148:151]
    ds_read_b128 v[128:131], v4 offset:14336
    s_waitcnt lgkmcnt(0) vmcnt(8)
    v_mfma_f32_16x16x32_bf16 v[132:135], v[112:115], v[72:75], v[132:135]
    ds_read_b128 v[92:95], v4 offset:20480
    v_mfma_f32_16x16x32_bf16 v[136:139], v[116:119], v[72:75], v[136:139]
    ds_read_b128 v[96:99], v4 offset:21504
    v_mfma_f32_16x16x32_bf16 v[140:143], v[120:123], v[72:75], v[140:143]
    ds_read_b128 v[100:103], v4 offset:22528
    v_mfma_f32_16x16x32_bf16 v[144:147], v[124:127], v[72:75], v[144:147]
    ds_read_b128 v[104:107], v4 offset:23552
    v_mfma_f32_16x16x32_bf16 v[148:151], v[128:131], v[72:75], v[148:151]
    ds_read_b128 v[108:111], v4 offset:24576
    s_cmp_eq_u32 s54, 1
    s_cbranch_scc1 k3x_114
    buffer_load_dwordx4 v[76:79], v8, s[28:31], 0 offen
    buffer_load_dwordx4 v[80:83], v8, s[28:31], 0 offen offset:64
    buffer_load_dwordx2 v[84:85], v9, s[28:31], 0 offen offset:128
k3x_114:
    s_waitcnt lgkmcnt(0) vmcnt(7)
    v_mfma_f32_16x16x32_bf16 v[132:135], v[92:95], v[12:15], v[132:135]
    ds_read_b128 v[112:115], v4 offset:30720
    v_mfma_f32_16x16x32_bf16 v[136:139], v[96:99], v[12:15], v[136:139]
    ds_read_b128 v[116:119], v4 offset:31744
    v_mfma_f32_16x16x32_bf16 v[140:143], v[100:103], v[12:15], v[140:143]
    ds_read_b128 v[120:123], v4 offset:32768
    v_mfma_f32_16x16x32_bf16 v[144:147], v[104:107], v[12:15], v[144:147]
    ds_read_b128 v[124:127], v4 offset:33792
    v_mfma_f32_16x16x32_bf16 v[148:151], v[108:111], v[12:15], v[148:151]
    ds_read_b128 v[128:131], v4 offset:34816
    s_waitcnt lgkmcnt(0) vmcnt(6)
    v_mfma_f32_16x16x32_bf16 v[132:135], v[112:115], v[16:19], v[132:135]
    ds_read_b128 v[92:95], v4 offset:40960
    v_mfma_f32_16x16x32_bf16 v[136:139], v[116:119], v[16:19], v[136:139]
    ds_read_b128 v[96:99], v4 offset:41984
    v_mfma_f32_16x16x32_bf16 v[140:143], v[120:123], v[16:19], v[140:143]
    ds_read_b128 v[100:103], v4 offset:43008
    v_mfma_f32_16x16x32_bf16 v[144:147], v[124:127], v[16:19], v[144:147]
    ds_read_b128 v[104:107], v4 offset:44032
    v_mfma_f32_16x16x32_bf16 v[148:151], v[128:131], v[16:19], v[148:151]
    ds_read_b128 v[108:111], v4 offset:45056
    s_waitcnt lgkmcnt(0) vmcnt(5)
    v_mfma_f32_16x16x32_bf16 v[132:135], v[92:95], v[20:23], v[132:135]
    ds_read_b128 v[112:115], v4 offset:51200
    v_mfma_f32_16x16x32_bf16 v[136:139], v[96:99], v[20:23], v[136:139]
    ds_read_b128 v[116:119], v4 offset:52224
    v_mfma_f32_16x16x32_bf16 v[140:143], v[100:103], v[20:23], v[140:143]
    ds_read_b128 v[120:123], v4 offset:53248
    v_mfma_f32_16x16x32_bf16 v[144:147], v[104:107], v[20:23], v[144:147]
    ds_read_b128 v[124:127], v4 offset:54272
    v_mfma_f32_16x16x32_bf16 v[148:151], v[108:111], v[20:23], v[148:151]
    ds_read_b128 v[128:131], v4 offset:55296
    s_waitcnt lgkmcnt(0) vmcnt(4)
    s_barrier
    v_mfma_f32_16x16x32_bf16 v[132:135], v[112:115], v[24:27], v[132:135]
    ds_read_b128 v[92:95], v5 offset:0
    v_mfma_f32_16x16x32_bf16 v[136:139], v[116:119], v[24:27], v[136:139]
    ds_read_b128 v[96:99], v5 offset:1024
    v_mfma_f32_16x16x32_bf16 v[140:143], v[120:123], v[24:27], v[140:143]
    ds_read_b128 v[100:103], v5 offset:2048
    v_mfma_f32_16x16x32_bf16 v[144:147], v[124:127], v[24:27], v[144:147]
    ds_read_b128 v[104:107], v5 offset:3072
    v_mfma_f32_16x16x32_bf16 v[148:151], v[128:131], v[24:27], v[148:151]
    ds_read_b128 v[108:111], v5 offset:4096
    s_waitcnt lgkmcnt(0) vmcnt(3)
    v_mfma_f32_16x16x32_bf16 v[132:135], v[92:95], v[28:31], v[132:135]
    ds_read_b128 v[112:115], v5 offset:10240
    v_mfma_f32_16x16x32_bf16 v[136:139], v[96:99], v[28:31], v[136:139]
    ds_read_b128 v[116:119], v5 offset:11264
    v_mfma_f32_16x16x32_bf16 v[140:143], v[100:103], v[28:31], v[140:143]
    ds_read_b128 v[120:123], v5 offset:12288
    v_mfma_f32_16x16x32_bf16 v[144:147], v[104:107], v[28:31], v[144:147]
    ds_read_b128 v[124:127], v5 offset:13312
    v_mfma_f32_16x16x32_bf16 v[148:151], v[108:111], v[28:31], v[148:151]
    ds_read_b128 v[128:131], v5 offset:14336
    s_waitcnt lgkmcnt(0) vmcnt(2)
    v_mfma_f32_16x16x32_bf16 v[132:135], v[112:115], v[32:35], v[132:135]
    ds_read_b128 v[92:95], v5 offset:20480
    v_mfma_f32_16x16x32_bf16 v[136:139], v[116:119], v[32:35], v[136:139]
    ds_read_b128 v[96:99], v5 offset:21504
    v_mfma_f32_16x16x32_bf16 v[140:143], v[120:123], v[32:35], v[140:143]
    ds_read_b128 v[100:103], v5 offset:22528
    v_mfma_f32_16x16x32_bf16 v[144:147], v[124:127], v[32:35], v[144:147]
    ds_read_b128 v[104:107], v5 offset:23552
    v_mfma_f32_16x16x32_bf16 v[148:151], v[128:131], v[32:35], v[148:151]
    ds_read_b128 v[108:111], v5 offset:24576
    s_waitcnt lgkmcnt(0) vmcnt(1)
    v_mfma_f32_16x16x32_bf16 v[132:135], v[92:95], v[36:39], v[132:135]
    ds_read_b128 v[112:115], v5 offset:30720
    v_mfma_f32_16x16x32_bf16 v[136:139], v[96:99], v[36:39], v[136:139]
    ds_read_b128 v[116:119], v5 offset:31744
    v_mfma_f32_16x16x32_bf16 v[140:143], v[100:103], v[36:39], v[140:143]
    ds_read_b128 v[120:123], v5 offset:32768
    v_mfma_f32_16x16x32_bf16 v[144:147], v[104:107], v[36:39], v[144:147]
    ds_read_b128 v[124:127], v5 offset:33792
    v_mfma_f32_16x16x32_bf16 v[148:151], v[108:111], v[36:39], v[148:151]
    ds_read_b128 v[128:131], v5 offset:34816
    s_cmp_eq_u32 s54, 1
    s_cbranch_scc1 k3s_103
    s_waitcnt lgkmcnt(0) vmcnt(0)
    v_mfma_f32_16x16x32_bf16 v[132:135], v[112:115], v[40:43], v[132:135]
    v_mfma_f32_16x16x32_bf16 v[136:139], v[116:119], v[40:43], v[136:139]
    v_mfma_f32_16x16x32_bf16 v[140:143], v[120:123], v[40:43], v[140:143]
    v_mfma_f32_16x16x32_bf16 v[144:147], v[124:127], v[40:43], v[144:147]
    v_mfma_f32_16x16x32_bf16 v[148:151], v[128:131], v[40:43], v[148:151]
    v_lshlrev_b32 v92, 16, v76
    v_and_b32 v93, s72, v76
    v_lshlrev_b32 v94, 16, v77
    v_and_b32 v95, s72, v77
    v_lshlrev_b32 v96, 16, v78
    v_and_b32 v97, s72, v78
    v_lshlrev_b32 v98, 16, v79
    v_and_b32 v99, s72, v79
    v_lshlrev_b32 v100, 16, v80
    v_and_b32 v101, s72, v80
    v_lshlrev_b32 v102, 16, v81
    v_and_b32 v103, s72, v81
    v_lshlrev_b32 v104, 16, v82
    v_and_b32 v105, s72, v82
    v_lshlrev_b32 v106, 16, v83
    v_and_b32 v107, s72, v83
    v_lshlrev_b32 v108, 16, v84
    v_and_b32 v109, s72, v84
    v_lshlrev_b32 v110, 16, v85
    v_and_b32 v111, s72, v85
    s_mul_i32 s57, s53, 5120
    s_add_u32 s57, s57, 106496
    v_add_u32 v3, s57, v1
    s_barrier
    ds_read_b128 v[52:55], v3 offset:0
    ds_read_b128 v[56:59], v3 offset:1024
    ds_read_b128 v[60:63], v3 offset:2048
    ds_read_b128 v[64:67], v3 offset:3072
    ds_read_b128 v[68:71], v3 offset:4096
    v_pk_add_f32 v[92:93], v[92:93], v[132:133]
    v_pk_add_f32 v[94:95], v[94:95], v[134:135]
    v_pk_add_f32 v[96:97], v[96:97], v[136:137]
    v_pk_add_f32 v[98:99], v[98:99], v[138:139]
    v_pk_add_f32 v[100:101], v[100:101], v[140:141]
    v_pk_add_f32 v[102:103], v[102:103], v[142:143]
    v_pk_add_f32 v[104:105], v[104:105], v[144:145]
    v_pk_add_f32 v[106:107], v[106:107], v[146:147]
    v_pk_add_f32 v[108:109], v[108:109], v[148:149]
    v_pk_add_f32 v[110:111], v[110:111], v[150:151]
    s_waitcnt lgkmcnt(0)
    v_pk_add_f32 v[92:93], v[92:93], v[52:53]
    v_pk_add_f32 v[94:95], v[94:95], v[54:55]
    v_pk_add_f32 v[96:97], v[96:97], v[56:57]
    v_pk_add_f32 v[98:99], v[98:99], v[58:59]
    v_pk_add_f32 v[100:101], v[100:101], v[60:61]
    v_pk_add_f32 v[102:103], v[102:103], v[62:63]
    v_pk_add_f32 v[104:105], v[104:105], v[64:65]
    v_pk_add_f32 v[106:107], v[106:107], v[66:67]
    v_pk_add_f32 v[108:109], v[108:109], v[68:69]
    v_pk_add_f32 v[110:111], v[110:111], v[70:71]
    v_cvt_pk_bf16_f32 v76, v92, v93
    v_cvt_pk_bf16_f32 v77, v94, v95
    v_cvt_pk_bf16_f32 v78, v96, v97
    v_cvt_pk_bf16_f32 v79, v98, v99
    v_cvt_pk_bf16_f32 v80, v100, v101
    v_cvt_pk_bf16_f32 v81, v102, v103
    v_cvt_pk_bf16_f32 v82, v104, v105
    v_cvt_pk_bf16_f32 v83, v106, v107
    v_cvt_pk_bf16_f32 v84, v108, v109
    v_cvt_pk_bf16_f32 v85, v110, v111
    buffer_store_dwordx4 v[76:79], v8, s[40:43], 0 offen
    buffer_store_dwordx4 v[80:83], v8, s[40:43], 0 offen offset:64
    buffer_store_dwordx2 v[84:85], v9, s[40:43], 0 offen offset:128
parallel_sum__linear_attn_block__mixer_gmlp__prompt_kernel_end:
    s_endpgm
k3s_103:
    s_mul_i32 s57, s53, 5120
    s_add_u32 s57, s57, 106496
    v_add_u32 v3, s57, v1
    ds_write_b128 v3, v[132:135] offset:0
    ds_write_b128 v3, v[136:139] offset:1024
    ds_write_b128 v3, v[140:143] offset:2048
    ds_write_b128 v3, v[144:147] offset:3072
    ds_write_b128 v3, v[148:151] offset:4096
    s_waitcnt lgkmcnt(0)
    s_barrier
    s_endpgm
k2load_95:
    s_setprio 3
    v_and_b32 v15, 15, v0
    v_bfe_u32 v16, v0, 4, 2
    v_xor_b32 v15, v15, v16
    s_and_b32 s57, s53, 1
    s_lshl_b32 s57, s57, 3
    v_xor_b32 v15, s57, v15
    s_lshl_b32 s57, s55, 6
    s_lshl_b32 s58, s53, 4
    s_add_u32 s57, s57, s58
    v_add_u32 v16, s57, v16
    v_lshlrev_b32 v16, 12, v16
    v_lshl_add_u32 v8, v15, 4, v16
    v_add_u32 v9, 15360, v8
    v_xor_b32 v15, 4, v15
    v_lshl_add_u32 v10, v15, 4, v16
    v_add_u32 v11, 46080, v10
    v_add_u32 v10, 30720, v10
    s_lshl_b32 s65, s53, 12
    s_waitcnt lgkmcnt(0)
    s_mov_b32 s28, s14
    s_mov_b32 s29, s15
    s_mov_b32 s30, 0x800000
    s_mov_b32 s31, 0x20000
    s_cmp_eq_u32 s56, 7
    s_cbranch_scc1 k2sl_97
    s_add_u32 s62, s62, 1280
    s_and_b32 s62, s62, 0xfff
    s_add_u32 m0, s65, 0
    s_nop 0
    buffer_load_dwordx4 v8, s[28:31], s62 offen offset:0 lds
    buffer_load_dwordx4 v9, s[28:31], s62 offen offset:1024 lds
    buffer_load_dwordx4 v10, s[28:31], s62 offen offset:2048 lds
    buffer_load_dwordx4 v11, s[28:31], s62 offen offset:3072 lds
    s_add_u32 s62, s62, 256
    s_and_b32 s62, s62, 0xfff
    s_add_u32 m0, s65, 16384
    s_nop 0
    buffer_load_dwordx4 v8, s[28:31], s62 offen offset:0 lds
    buffer_load_dwordx4 v9, s[28:31], s62 offen offset:1024 lds
    buffer_load_dwordx4 v10, s[28:31], s62 offen offset:2048 lds
    buffer_load_dwordx4 v11, s[28:31], s62 offen offset:3072 lds
    s_add_u32 s62, s62, 256
    s_and_b32 s62, s62, 0xfff
    s_add_u32 m0, s65, 32768
    s_nop 0
    buffer_load_dwordx4 v8, s[28:31], s62 offen offset:0 lds
    buffer_load_dwordx4 v9, s[28:31], s62 offen offset:1024 lds
    buffer_load_dwordx4 v10, s[28:31], s62 offen offset:2048 lds
    buffer_load_dwordx4 v11, s[28:31], s62 offen offset:3072 lds
    s_add_u32 s62, s62, 256
    s_and_b32 s62, s62, 0xfff
    s_add_u32 m0, s65, 49152
    s_nop 0
    buffer_load_dwordx4 v8, s[28:31], s62 offen offset:0 lds
    buffer_load_dwordx4 v9, s[28:31], s62 offen offset:1024 lds
    buffer_load_dwordx4 v10, s[28:31], s62 offen offset:2048 lds
    buffer_load_dwordx4 v11, s[28:31], s62 offen offset:3072 lds
    s_add_u32 s62, s62, 256
    s_and_b32 s62, s62, 0xfff
    s_add_u32 s32, s24, 0x1800000
    s_addc_u32 s33, s25, 0
    s_mov_b32 s34, 0x1d6000
    s_mov_b32 s35, 0x20000
    s_add_u32 s48, s24, 0xb40000
    s_addc_u32 s49, s25, 0
    s_mov_b32 s50, 0x3800
    s_mov_b32 s51, 0x20000
    s_mul_i32 s67, s56, 240640
    s_and_b32 s57, s53, 1
    s_mul_i32 s58, s57, 3072
    s_lshl_b32 s57, s57, 11
    s_add_u32 s57, s57, 6144
    s_lshr_b32 s70, s53, 1
    s_cmp_eq_u32 s70, 0
    s_cselect_b32 s68, s58, s57
    s_cselect_b32 s69, s57, s58
    v_add_u32 v12, s68, v1
    v_add_u32 v13, s69, v1
    v_and_b32 v17, 7, v0
    v_lshlrev_b32 v17, 7, v17
    v_add_u32 v17, 8192, v17
    s_barrier
    s_cmp_lg_u32 s53, 0
    s_cbranch_scc1 k2r_115
    s_lshl_b32 s59, s56, 2
    s_lshr_b32 s58, s55, 3
    s_add_u32 s59, s59, s58
    s_add_u32 s59, s59, 32
    s_lshl_b32 s59, s59, 7
    s_cmp_eq_u32 s56, 6
    s_cselect_b32 s58, 16, 32
    s_sleep 10
    buffer_load_dword v16, v2, s[48:51], s59 offen sc1
k2r_115:
    s_waitcnt vmcnt(19)
    s_barrier
    s_cmp_lg_u32 s53, 0
    s_cbranch_scc1 k2r_116
    s_waitcnt vmcnt(0)
    v_cmp_gt_u32 vcc, s58, v16
    s_nop 1
    s_cbranch_vccz k2r_116
    s_mov_b32 s64, 0
pp_119:
    buffer_load_dword v16, v2, s[48:51], s59 offen sc1
    s_add_u32 s64, s64, 1
    s_waitcnt vmcnt(0)
    v_cmp_eq_u32 vcc, 0, v16
    s_cmp_ge_u32 s64, 262144
    s_cbranch_scc1 pp_118
    s_cbranch_vccz pp_120
    s_sleep 12
    s_branch pp_119
pp_120:
    v_cmp_gt_u32 vcc, s58, v16
    s_nop 1
    s_cbranch_vccz pp_118
    buffer_load_dword v16, v2, s[48:51], s59 offen sc1
    s_sleep 4
pp_117:
    buffer_load_dword v15, v2, s[48:51], s59 offen sc1
    s_waitcnt vmcnt(1)
    v_cmp_gt_u32 vcc, s58, v16
    s_nop 1
    s_cbranch_vccz pp_118
    s_sleep 2
    buffer_load_dword v16, v2, s[48:51], s59 offen sc1
    s_waitcnt vmcnt(1)
    v_cmp_gt_u32 vcc, s58, v15
    s_nop 1
    s_cbranch_vccz pp_118
    s_sleep 2
    s_add_u32 s64, s64, 1
    s_cmp_lt_u32 s64, 262144
    s_cbranch_scc1 pp_117
pp_118:
k2r_116:
    s_waitcnt vmcnt(18)
    s_barrier
    s_waitcnt vmcnt(17)
    s_barrier
    s_add_u32 m0, s65, 65536
    s_nop 0
    buffer_load_dwordx4 v8, s[28:31], s62 offen offset:0 lds
    buffer_load_dwordx4 v9, s[28:31], s62 offen offset:1024 lds
    buffer_load_dwordx4 v10, s[28:31], s62 offen offset:2048 lds
    buffer_load_dwordx4 v11, s[28:31], s62 offen offset:3072 lds
    s_add_u32 s62, s62, 256
    s_and_b32 s62, s62, 0xfff
    s_waitcnt vmcnt(20)
    s_barrier
    s_waitcnt vmcnt(16)
    s_barrier
    s_add_u32 m0, s65, 81920
    s_nop 0
    buffer_load_dwordx4 v8, s[28:31], s62 offen offset:0 lds
    buffer_load_dwordx4 v9, s[28:31], s62 offen offset:1024 lds
    buffer_load_dwordx4 v10, s[28:31], s62 offen offset:2048 lds
    buffer_load_dwordx4 v11, s[28:31], s62 offen offset:3072 lds
    s_add_u32 s62, s62, 256
    s_and_b32 s62, s62, 0xfff
    s_waitcnt vmcnt(16)
    s_barrier
    s_add_u32 m0, s65, 98304
    s_nop 0
    buffer_load_dwordx4 v8, s[28:31], s62 offen offset:0 lds
    buffer_load_dwordx4 v9, s[28:31], s62 offen offset:1024 lds
    buffer_load_dwordx4 v10, s[28:31], s62 offen offset:2048 lds
    buffer_load_dwordx4 v11, s[28:31], s62 offen offset:3072 lds
    s_add_u32 s62, s62, 256
    s_and_b32 s62, s62, 0xfff
    s_waitcnt vmcnt(16)
    s_barrier
    s_waitcnt vmcnt(12)
    s_barrier
    s_add_u32 m0, s65, 114688
    s_nop 0
    buffer_load_dwordx4 v8, s[28:31], s62 offen offset:0 lds
    buffer_load_dwordx4 v9, s[28:31], s62 offen offset:1024 lds
    buffer_load_dwordx4 v10, s[28:31], s62 offen offset:2048 lds
    buffer_load_dwordx4 v11, s[28:31], s62 offen offset:3072 lds
    s_add_u32 s62, s62, 256
    s_and_b32 s62, s62, 0xfff
    s_cmp_lg_u32 s53, 0
    s_cbranch_scc1 k2r_121
    buffer_load_dword v16, v17, s[48:51], 0 offen sc1
k2r_121:
    s_waitcnt vmcnt(12)
    s_barrier
    s_add_u32 m0, s65, 131072
    s_nop 0
    buffer_load_dwordx4 v8, s[28:31], s62 offen offset:0 lds
    buffer_load_dwordx4 v9, s[28:31], s62 offen offset:1024 lds
    buffer_load_dwordx4 v10, s[28:31], s62 offen offset:2048 lds
    buffer_load_dwordx4 v11, s[28:31], s62 offen offset:3072 lds
    s_add_u32 s62, s62, 256
    s_and_b32 s62, s62, 0xfff
    s_waitcnt vmcnt(12)
    s_barrier
    s_waitcnt vmcnt(8)
    s_barrier
    s_add_u32 m0, s65, 65536
    s_nop 0
    buffer_load_dwordx4 v8, s[28:31], s62 offen offset:0 lds
    buffer_load_dwordx4 v9, s[28:31], s62 offen offset:1024 lds
    buffer_load_dwordx4 v10, s[28:31], s62 offen offset:2048 lds
    buffer_load_dwordx4 v11, s[28:31], s62 offen offset:3072 lds
    s_add_u32 s62, s62, 256
    s_and_b32 s62, s62, 0xfff
    s_cmp_lg_u32 s53, 0
    s_cbranch_scc1 k2r_122
    s_waitcnt vmcnt(8)
    v_cmp_gt_u32 vcc, 16, v16
    s_nop 1
    s_cbranch_vccz k2r_122
    s_mov_b32 s64, 0
pp_125:
    buffer_load_dword v16, v17, s[48:51], 0 offen sc1
    s_add_u32 s64, s64, 1
    s_waitcnt vmcnt(0)
    v_cmp_eq_u32 vcc, 0, v16
    s_cmp_ge_u32 s64, 262144
    s_cbranch_scc1 pp_124
    s_cbranch_vccz pp_126
    s_sleep 12
    s_branch pp_125
pp_126:
    v_cmp_gt_u32 vcc, 16, v16
    s_nop 1
    s_cbranch_vccz pp_124
    buffer_load_dword v16, v17, s[48:51], 0 offen sc1
    s_sleep 4
pp_123:
    buffer_load_dword v15, v17, s[48:51], 0 offen sc1
    s_waitcnt vmcnt(1)
    v_cmp_gt_u32 vcc, 16, v16
    s_nop 1
    s_cbranch_vccz pp_124
    s_sleep 2
    buffer_load_dword v16, v17, s[48:51], 0 offen sc1
    s_waitcnt vmcnt(1)
    v_cmp_gt_u32 vcc, 16, v15
    s_nop 1
    s_cbranch_vccz pp_124
    s_sleep 2
    s_add_u32 s64, s64, 1
    s_cmp_lt_u32 s64, 262144
    s_cbranch_scc1 pp_123
pp_124:
    s_waitcnt vmcnt(0)
k2r_122:
    s_waitcnt vmcnt(8)
    s_barrier
    s_add_u32 m0, s65, 81920
    s_nop 0
    buffer_load_dwordx4 v8, s[28:31], s62 offen offset:0 lds
    buffer_load_dwordx4 v9, s[28:31], s62 offen offset:1024 lds
    buffer_load_dwordx4 v10, s[28:31], s62 offen offset:2048 lds
    buffer_load_dwordx4 v11, s[28:31], s62 offen offset:3072 lds
    s_add_u32 s62, s62, 256
    s_and_b32 s62, s62, 0xfff
    s_waitcnt vmcnt(8)
    s_barrier
    buffer_load_dword v14, v2, s[48:51], s71 offen offset:64 sc1
    s_add_u32 m0, s68, 0
    s_nop 0
    buffer_load_dwordx4 v12, s[32:35], s67 offen lds
    buffer_load_dwordx4 v12, s[32:35], s67 offen offset:1024 lds
    s_cmp_lg_u32 s70, 0
    s_cbranch_scc1 k3b_127
    buffer_load_dwordx4 v12, s[32:35], s67 offen offset:2048 lds
k3b_127:
    s_add_u32 s67, s67, 10240
    s_add_u32 m0, s69, 10240
    s_nop 0
    buffer_load_dwordx4 v13, s[32:35], s67 offen lds
    buffer_load_dwordx4 v13, s[32:35], s67 offen offset:1024 lds
    s_cmp_lg_u32 s70, 1
    s_cbranch_scc1 k3b_128
    buffer_load_dwordx4 v13, s[32:35], s67 offen offset:2048 lds
k3b_128:
    s_add_u32 s67, s67, 10240
    s_waitcnt vmcnt(9)
    s_barrier
    s_add_u32 m0, s68, 20480
    s_nop 0
    buffer_load_dwordx4 v12, s[32:35], s67 offen lds
    buffer_load_dwordx4 v12, s[32:35], s67 offen offset:1024 lds
    s_cmp_lg_u32 s70, 0
    s_cbranch_scc1 k3b_129
    buffer_load_dwordx4 v12, s[32:35], s67 offen offset:2048 lds
k3b_129:
    s_add_u32 s67, s67, 10240
    s_add_u32 m0, s69, 30720
    s_nop 0
    buffer_load_dwordx4 v13, s[32:35], s67 offen lds
    buffer_load_dwordx4 v13, s[32:35], s67 offen offset:1024 lds
    s_cmp_lg_u32 s70, 1
    s_cbranch_scc1 k3b_130
    buffer_load_dwordx4 v13, s[32:35], s67 offen offset:2048 lds
k3b_130:
    s_add_u32 s67, s67, 10240
    s_waitcnt vmcnt(8)
    s_cmp_lg_u32 s53, 0
    s_cbranch_scc1 k2q_131
    s_mov_b32 s64, 0
sp_132:
    v_readfirstlane_b32 s57, v14
    s_add_u32 s64, s64, 1
    s_cmp_ge_u32 s57, 32
    s_cbranch_scc1 sp_133
    s_cmp_ge_u32 s64, 262144
    s_cbranch_scc1 sp_133
    s_cmp_lg_u32 s57, 0
    s_cbranch_scc1 sp_134
    s_sleep 16
sp_134:
    s_sleep 1
    buffer_load_dword v14, v2, s[48:51], s71 offen offset:64 sc1
    s_waitcnt vmcnt(0)
    s_branch sp_132
sp_133:
k2q_131:
    s_waitcnt vmcnt(9)
    s_barrier
    s_add_u32 m0, s68, 40960
    s_nop 0
    buffer_load_dwordx4 v12, s[32:35], s67 offen lds
    buffer_load_dwordx4 v12, s[32:35], s67 offen offset:1024 lds
    s_cmp_lg_u32 s70, 0
    s_cbranch_scc1 k3b_135
    buffer_load_dwordx4 v12, s[32:35], s67 offen offset:2048 lds
k3b_135:
    s_add_u32 s67, s67, 10240
    s_add_u32 m0, s69, 51200
    s_nop 0
    buffer_load_dwordx4 v13, s[32:35], s67 offen lds
    buffer_load_dwordx4 v13, s[32:35], s67 offen offset:1024 lds
    s_cmp_lg_u32 s70, 1
    s_cbranch_scc1 k3b_136
    buffer_load_dwordx4 v13, s[32:35], s67 offen offset:2048 lds
k3b_136:
    s_add_u32 s67, s67, 10240
    s_barrier
k3load_96:
    s_waitcnt vmcnt(0)
    s_barrier
    s_add_u32 m0, s68, 65536
    s_nop 0
    buffer_load_dwordx4 v12, s[32:35], s67 offen lds
    buffer_load_dwordx4 v12, s[32:35], s67 offen offset:1024 lds
    s_cmp_lg_u32 s70, 0
    s_cbranch_scc1 k3b_137
    buffer_load_dwordx4 v12, s[32:35], s67 offen offset:2048 lds
k3b_137:
    s_add_u32 s67, s67, 10240
    s_add_u32 m0, s69, 75776
    s_nop 0
    buffer_load_dwordx4 v13, s[32:35], s67 offen lds
    buffer_load_dwordx4 v13, s[32:35], s67 offen offset:1024 lds
    s_cmp_lg_u32 s70, 1
    s_cbranch_scc1 k3b_138
    buffer_load_dwordx4 v13, s[32:35], s67 offen offset:2048 lds
k3b_138:
    s_add_u32 s67, s67, 10240
    s_add_u32 m0, s68, 86016
    s_nop 0
    buffer_load_dwordx4 v12, s[32:35], s67 offen lds
    buffer_load_dwordx4 v12, s[32:35], s67 offen offset:1024 lds
    s_cmp_lg_u32 s70, 0
    s_cbranch_scc1 k3b_139
    buffer_load_dwordx4 v12, s[32:35], s67 offen offset:2048 lds
k3b_139:
    s_add_u32 s67, s67, 10240
    s_add_u32 m0, s69, 96256
    s_nop 0
    buffer_load_dwordx4 v13, s[32:35], s67 offen lds
    buffer_load_dwordx4 v13, s[32:35], s67 offen offset:1024 lds
    s_cmp_lg_u32 s70, 1
    s_cbranch_scc1 k3b_140
    buffer_load_dwordx4 v13, s[32:35], s67 offen offset:2048 lds
k3b_140:
    s_add_u32 s67, s67, 10240
    s_add_u32 m0, s68, 106496
    s_nop 0
    buffer_load_dwordx4 v12, s[32:35], s67 offen lds
    buffer_load_dwordx4 v12, s[32:35], s67 offen offset:1024 lds
    s_cmp_lg_u32 s70, 0
    s_cbranch_scc1 k3b_141
    buffer_load_dwordx4 v12, s[32:35], s67 offen offset:2048 lds
k3b_141:
    s_add_u32 s67, s67, 10240
    s_add_u32 m0, s69, 116736
    s_nop 0
    buffer_load_dwordx4 v13, s[32:35], s67 offen lds
    buffer_load_dwordx4 v13, s[32:35], s67 offen offset:1024 lds
    s_cmp_lg_u32 s70, 1
    s_cbranch_scc1 k3b_142
    buffer_load_dwordx4 v13, s[32:35], s67 offen offset:2048 lds
k3b_142:
    s_add_u32 s67, s67, 10240
    s_add_u32 m0, s68, 126976
    s_nop 0
    buffer_load_dwordx4 v12, s[32:35], s67 offen lds
    buffer_load_dwordx4 v12, s[32:35], s67 offen offset:1024 lds
    s_cmp_lg_u32 s70, 0
    s_cbranch_scc1 k3b_143
    buffer_load_dwordx4 v12, s[32:35], s67 offen offset:2048 lds
k3b_143:
    s_add_u32 s67, s67, 10240
    s_add_u32 m0, s69, 137216
    s_nop 0
    buffer_load_dwordx4 v13, s[32:35], s67 offen lds
    buffer_load_dwordx4 v13, s[32:35], s67 offen offset:1024 lds
    s_cmp_lg_u32 s70, 1
    s_cbranch_scc1 k3b_144
    buffer_load_dwordx4 v13, s[32:35], s67 offen offset:2048 lds
k3b_144:
    s_add_u32 s67, s67, 10240
    s_waitcnt vmcnt(8)
    s_barrier
    s_add_u32 m0, s68, 0
    s_nop 0
    buffer_load_dwordx4 v12, s[32:35], s67 offen lds
    buffer_load_dwordx4 v12, s[32:35], s67 offen offset:1024 lds
    s_cmp_lg_u32 s70, 0
    s_cbranch_scc1 k3b_145
    buffer_load_dwordx4 v12, s[32:35], s67 offen offset:2048 lds
k3b_145:
    s_add_u32 s67, s67, 10240
    s_add_u32 m0, s69, 10240
    s_nop 0
    buffer_load_dwordx4 v13, s[32:35], s67 offen lds
    buffer_load_dwordx4 v13, s[32:35], s67 offen offset:1024 lds
    s_cmp_lg_u32 s70, 1
    s_cbranch_scc1 k3b_146
    buffer_load_dwordx4 v13, s[32:35], s67 offen offset:2048 lds
k3b_146:
    s_add_u32 s67, s67, 10240
    s_add_u32 m0, s68, 20480
    s_nop 0
    buffer_load_dwordx4 v12, s[32:35], s67 offen lds
    buffer_load_dwordx4 v12, s[32:35], s67 offen offset:1024 lds
    s_cmp_lg_u32 s70, 0
    s_cbranch_scc1 k3b_147
    buffer_load_dwordx4 v12, s[32:35], s67 offen offset:2048 lds
k3b_147:
    s_add_u32 s67, s67, 10240
    s_add_u32 m0, s69, 30720
    s_nop 0
    buffer_load_dwordx4 v13, s[32:35], s67 offen lds
    buffer_load_dwordx4 v13, s[32:35], s67 offen offset:1024 lds
    s_cmp_lg_u32 s70, 1
    s_cbranch_scc1 k3b_148
    buffer_load_dwordx4 v13, s[32:35], s67 offen offset:2048 lds
k3b_148:
    s_add_u32 s67, s67, 10240
    s_add_u32 m0, s68, 40960
    s_nop 0
    buffer_load_dwordx4 v12, s[32:35], s67 offen lds
    buffer_load_dwordx4 v12, s[32:35], s67 offen offset:1024 lds
    s_cmp_lg_u32 s70, 0
    s_cbranch_scc1 k3b_149
    buffer_load_dwordx4 v12, s[32:35], s67 offen offset:2048 lds
k3b_149:
    s_add_u32 s67, s67, 10240
    s_add_u32 m0, s69, 51200
    s_nop 0
    buffer_load_dwordx4 v13, s[32:35], s67 offen lds
    buffer_load_dwordx4 v13, s[32:35], s67 offen offset:1024 lds
    s_cmp_lg_u32 s70, 1
    s_cbranch_scc1 k3b_150
    buffer_load_dwordx4 v13, s[32:35], s67 offen offset:2048 lds
k3b_150:
    s_add_u32 s67, s67, 10240
    s_waitcnt vmcnt(10)
    s_barrier
    s_add_u32 m0, s68, 65536
    s_nop 0
    buffer_load_dwordx4 v12, s[32:35], s67 offen lds
    buffer_load_dwordx4 v12, s[32:35], s67 offen offset:1024 lds
    s_cmp_lg_u32 s70, 0
    s_cbranch_scc1 k3b_151
    buffer_load_dwordx4 v12, s[32:35], s67 offen offset:2048 lds
k3b_151:
    s_add_u32 s67, s67, 10240
    s_add_u32 m0, s69, 75776
    s_nop 0
    buffer_load_dwordx4 v13, s[32:35], s67 offen lds
    buffer_load_dwordx4 v13, s[32:35], s67 offen offset:1024 lds
    s_cmp_lg_u32 s70, 1
    s_cbranch_scc1 k3b_152
    buffer_load_dwordx4 v13, s[32:35], s67 offen offset:2048 lds
k3b_152:
    s_add_u32 s67, s67, 10240
    s_add_u32 m0, s68, 86016
    s_nop 0
    buffer_load_dwordx4 v12, s[32:35], s67 offen lds
    buffer_load_dwordx4 v12, s[32:35], s67 offen offset:1024 lds
    s_cmp_lg_u32 s70, 0
    s_cbranch_scc1 k3b_153
    buffer_load_dwordx4 v12, s[32:35], s67 offen offset:2048 lds
k3b_153:
    s_add_u32 s67, s67, 10240
    s_add_u32 m0, s69, 96256
    s_nop 0
    buffer_load_dwordx4 v13, s[32:35], s67 offen lds
    buffer_load_dwordx4 v13, s[32:35], s67 offen offset:1024 lds
    s_cmp_lg_u32 s70, 1
    s_cbranch_scc1 k3b_154
    buffer_load_dwordx4 v13, s[32:35], s67 offen offset:2048 lds
k3b_154:
    s_add_u32 s67, s67, 10240
    s_barrier
    s_waitcnt vmcnt(8)
    s_barrier
    s_waitcnt vmcnt(0)
    s_barrier
    s_endpgm
k2sl_97:
    s_add_u32 s32, s24, 0x1800000
    s_addc_u32 s33, s25, 0
    s_mov_b32 s34, 0x1d6000
    s_mov_b32 s35, 0x20000
    s_add_u32 s48, s24, 0xb40000
    s_addc_u32 s49, s25, 0
    s_mov_b32 s50, 0x3800
    s_mov_b32 s51, 0x20000
    s_mul_i32 s67, s56, 240640
    s_and_b32 s57, s53, 1
    s_mul_i32 s58, s57, 3072
    s_lshl_b32 s57, s57, 11
    s_add_u32 s57, s57, 6144
    s_lshr_b32 s70, s53, 1
    s_cmp_eq_u32 s70, 0
    s_cselect_b32 s68, s58, s57
    s_cselect_b32 s69, s57, s58
    v_add_u32 v12, s68, v1
    v_add_u32 v13, s69, v1
    s_barrier
    s_barrier
    s_barrier
    s_cmp_lg_u32 s53, 0
    s_cbranch_scc1 k2q_155
    v_mov_b32 v14, 0
    s_mov_b32 s64, 0
sp_156:
    v_readfirstlane_b32 s57, v14
    s_add_u32 s64, s64, 1
    s_cmp_ge_u32 s57, 32
    s_cbranch_scc1 sp_157
    s_cmp_ge_u32 s64, 262144
    s_cbranch_scc1 sp_157
    s_cmp_lg_u32 s57, 0
    s_cbranch_scc1 sp_158
    s_sleep 16
sp_158:
    s_sleep 1
    buffer_load_dword v14, v2, s[48:51], s71 offen offset:64 sc1
    s_waitcnt vmcnt(0)
    s_branch sp_156
sp_157:
k2q_155:
    s_barrier
    s_add_u32 m0, s68, 0
    s_nop 0
    buffer_load_dwordx4 v12, s[32:35], s67 offen lds
    buffer_load_dwordx4 v12, s[32:35], s67 offen offset:1024 lds
    s_cmp_lg_u32 s70, 0
    s_cbranch_scc1 k3b_159
    buffer_load_dwordx4 v12, s[32:35], s67 offen offset:2048 lds
k3b_159:
    s_add_u32 s67, s67, 10240
    s_add_u32 m0, s69, 10240
    s_nop 0
    buffer_load_dwordx4 v13, s[32:35], s67 offen lds
    buffer_load_dwordx4 v13, s[32:35], s67 offen offset:1024 lds
    s_cmp_lg_u32 s70, 1
    s_cbranch_scc1 k3b_160
    buffer_load_dwordx4 v13, s[32:35], s67 offen offset:2048 lds
k3b_160:
    s_add_u32 s67, s67, 10240
    s_add_u32 m0, s68, 20480
    s_nop 0
    buffer_load_dwordx4 v12, s[32:35], s67 offen lds
    buffer_load_dwordx4 v12, s[32:35], s67 offen offset:1024 lds
    s_cmp_lg_u32 s70, 0
    s_cbranch_scc1 k3b_161
    buffer_load_dwordx4 v12, s[32:35], s67 offen offset:2048 lds
k3b_161:
    s_add_u32 s67, s67, 10240
    s_add_u32 m0, s69, 30720
    s_nop 0
    buffer_load_dwordx4 v13, s[32:35], s67 offen lds
    buffer_load_dwordx4 v13, s[32:35], s67 offen offset:1024 lds
    s_cmp_lg_u32 s70, 1
    s_cbranch_scc1 k3b_162
    buffer_load_dwordx4 v13, s[32:35], s67 offen offset:2048 lds
k3b_162:
    s_add_u32 s67, s67, 10240
    s_add_u32 m0, s68, 40960
    s_nop 0
    buffer_load_dwordx4 v12, s[32:35], s67 offen lds
    buffer_load_dwordx4 v12, s[32:35], s67 offen offset:1024 lds
    s_cmp_lg_u32 s70, 0
    s_cbranch_scc1 k3b_163
    buffer_load_dwordx4 v12, s[32:35], s67 offen offset:2048 lds
k3b_163:
    s_add_u32 s67, s67, 10240
    s_add_u32 m0, s69, 51200
    s_nop 0
    buffer_load_dwordx4 v13, s[32:35], s67 offen lds
    buffer_load_dwordx4 v13, s[32:35], s67 offen offset:1024 lds
    s_cmp_lg_u32 s70, 1
    s_cbranch_scc1 k3b_164
    buffer_load_dwordx4 v13, s[32:35], s67 offen offset:2048 lds
k3b_164:
    s_add_u32 s67, s67, 10240
    s_branch k3load_96
k2side_93:
    s_lshr_b32 s62, s55, 2
    s_and_b32 s58, s55, 3
    s_lshl_b32 s58, s58, 4
    s_lshl_b32 s59, s52, 1
    s_add_u32 s61, s58, s59
    s_mul_i32 s58, s61, 94
    s_mul_i32 s59, s62, 5
    s_add_u32 s58, s58, s59
    s_lshl_b32 s58, s58, 10
    v_and_b32 v133, 63, v0
    v_and_b32 v131, 15, v0
    v_bfe_u32 v132, v0, 4, 2
    s_waitcnt lgkmcnt(0)
    s_mov_b32 s32, s24
    s_mov_b32 s33, s25
    s_mov_b32 s34, 0x5e0000
    s_mov_b32 s35, 0x20000
    s_add_u32 s28, s24, 0xc00000
    s_addc_u32 s29, s25, 0
    s_mov_b32 s30, 0x1e0000
    s_mov_b32 s31, 0x20000
    s_add_u32 s44, s24, 0xe00000
    s_addc_u32 s45, s25, 0
    s_mov_b32 s46, 0x5e0000
    s_mov_b32 s47, 0x20000
    s_add_u32 s48, s24, 0xb40000
    s_addc_u32 s49, s25, 0
    s_mov_b32 s50, 0x3800
    s_mov_b32 s51, 0x20000
    v_mul_u32_u24 v3, 3277, v0
    v_lshrrev_b32 v3, 16, v3
    v_mul_u32_u24 v128, 20, v3
    v_sub_u32 v128, v0, v128
    v_mul_u32_u24 v129, 52, v3
    v_lshrrev_b32 v129, 8, v129
    v_mad_u32_u24 v128, v129, 20, v128
    v_lshrrev_b32 v129, 2, v3
    v_lshrrev_b32 v14, 4, v128
    v_lshl_add_u32 v129, v129, 1, v14
    v_add_u32 v129, 1, v129
    v_and_b32 v3, 3, v3
    v_lshl_add_u32 v129, v129, 2, v3
    v_and_b32 v128, 15, v128
    v_lshl_add_u32 v129, v129, 4, v128
    v_lshlrev_b32 v15, 3, v129
    v_add_u32 v15, 65536, v15
    v_lshlrev_b32 v129, 4, v129
    v_mov_b32 v14, 1073741824
    v_mov_b32 v3, 73728
    v_cmp_gt_u32 vcc, 400, v0
    s_nop 1
    v_cndmask_b32 v129, v14, v129, vcc
    v_cndmask_b32 v15, v3, v15, vcc
    s_mul_i32 s57, s62, 15360
    s_mov_b32 s60, 122880
    s_cmp_lg_u32 s52, 7
    s_cbranch_scc1 k2z2_165
    s_add_u32 s28, s24, 0xb20000
    s_addc_u32 s29, s25, 0
    s_mov_b32 s30, 0xa000
    s_mov_b32 s31, 0x20000
    s_mul_i32 s57, s62, 320
    s_movk_i32 s60, 2560
    v_cmp_gt_u32 vcc, 20, v133
    s_nop 1
    v_cndmask_b32 v129, v14, v1, vcc
    v_lshlrev_b32 v15, 3, v133
    v_add_u32 v15, 73216, v15
k2z2_165:
    v_lshrrev_b32 v130, 2, v131
    s_mov_b32 s76, 0x358637bd
    s_cmp_lg_u32 s52, 0
    s_cbranch_scc1 k2g_166
    s_mul_i32 s64, s62, 5
    v_and_b32 v140, 2, v131
    v_lshl_add_u32 v140, v140, 1, s64
    v_lshrrev_b32 v140, 2, v140
    v_cmp_gt_u32 vcc, 8, v140
    s_nop 1
    v_cndmask_b32 v140, 15, v140, vcc
    v_mov_b32 v141, s62
    v_and_b32 v142, 3, v131
    v_cmp_ne_u32 vcc, 0, v142
    s_nop 1
    v_cndmask_b32 v140, v141, v140, vcc
    v_lshlrev_b32 v140, 7, v140
    v_add_u32 v140, 8192, v140
    s_mov_b32 s64, 0
pp_169:
    buffer_load_dword v141, v140, s[48:51], 0 offen sc1
    s_add_u32 s64, s64, 1
    s_waitcnt vmcnt(0)
    v_cmp_eq_u32 vcc, 0, v141
    s_cmp_ge_u32 s64, 262144
    s_cbranch_scc1 pp_168
    s_cbranch_vccz pp_170
    s_sleep 12
    s_branch pp_169
pp_170:
    v_cmp_gt_u32 vcc, 16, v141
    s_nop 1
    s_cbranch_vccz pp_168
    buffer_load_dword v141, v140, s[48:51], 0 offen sc1
    s_sleep 4
pp_167:
    buffer_load_dword v142, v140, s[48:51], 0 offen sc1
    s_waitcnt vmcnt(1)
    v_cmp_gt_u32 vcc, 16, v141
    s_nop 1
    s_cbranch_vccz pp_168
    s_sleep 2
    buffer_load_dword v141, v140, s[48:51], 0 offen sc1
    s_waitcnt vmcnt(1)
    v_cmp_gt_u32 vcc, 16, v142
    s_nop 1
    s_cbranch_vccz pp_168
    s_sleep 2
    s_add_u32 s64, s64, 1
    s_cmp_lt_u32 s64, 262144
    s_cbranch_scc1 pp_167
pp_168:
k2g_166:
    s_barrier
    buffer_load_dwordx4 v[16:19], v129, s[28:31], s57 offen
    s_add_u32 s57, s57, s60
    buffer_load_dwordx4 v[20:23], v129, s[28:31], s57 offen
    s_add_u32 s57, s57, s60
    buffer_load_dwordx4 v[24:27], v129, s[28:31], s57 offen
    s_add_u32 s57, s57, s60
    buffer_load_dwordx4 v[28:31], v129, s[28:31], s57 offen
    s_add_u32 s57, s57, s60
    buffer_load_dwordx4 v[32:35], v129, s[28:31], s57 offen
    s_add_u32 s57, s57, s60
    buffer_load_dwordx4 v[36:39], v129, s[28:31], s57 offen
    s_add_u32 s57, s57, s60
    buffer_load_dwordx4 v[40:43], v129, s[28:31], s57 offen
    s_add_u32 s57, s57, s60
    buffer_load_dwordx4 v[44:47], v129, s[28:31], s57 offen
    s_add_u32 s57, s57, s60
    buffer_load_dwordx4 v[48:51], v129, s[28:31], s57 offen
    s_add_u32 s57, s57, s60
    buffer_load_dwordx4 v[52:55], v129, s[28:31], s57 offen
    s_add_u32 s57, s57, s60
    buffer_load_dwordx4 v[56:59], v129, s[28:31], s57 offen
    s_add_u32 s57, s57, s60
    buffer_load_dwordx4 v[60:63], v129, s[28:31], s57 offen
    s_add_u32 s57, s57, s60
    buffer_load_dwordx4 v[64:67], v129, s[28:31], s57 offen
    s_add_u32 s57, s57, s60
    buffer_load_dwordx4 v[68:71], v129, s[28:31], s57 offen
    s_add_u32 s57, s57, s60
    buffer_load_dwordx4 v[72:75], v129, s[28:31], s57 offen
    s_add_u32 s57, s57, s60
    buffer_load_dwordx4 v[76:79], v129, s[28:31], s57 offen
    s_add_u32 s57, s57, s60
    buffer_load_dwordx4 v[88:91], v1, s[32:35], s58 offen offset:0
    buffer_load_dwordx4 v[92:95], v1, s[32:35], s58 offen offset:1024
    buffer_load_dwordx4 v[96:99], v1, s[32:35], s58 offen offset:2048
    buffer_load_dwordx4 v[100:103], v1, s[32:35], s58 offen offset:3072
    s_add_u32 s58, s58, 4096
    buffer_load_dwordx4 v[104:107], v1, s[32:35], s58 offen offset:0
    s_add_u32 s58, s58, 92160
    buffer_load_dwordx4 v[108:111], v1, s[32:35], s58 offen offset:0
    buffer_load_dwordx4 v[112:115], v1, s[32:35], s58 offen offset:1024
    buffer_load_dwordx4 v[116:119], v1, s[32:35], s58 offen offset:2048
    buffer_load_dwordx4 v[120:123], v1, s[32:35], s58 offen offset:3072
    s_add_u32 s58, s58, 4096
    buffer_load_dwordx4 v[124:127], v1, s[32:35], s58 offen offset:0
    v_add_u32 v128, 5, v132
    v_mul_u32_u24 v128, 52, v128
    v_lshrrev_b32 v4, 8, v128
    v_add_u32 v128, 5, v130
    v_mul_u32_u24 v128, 52, v128
    v_lshrrev_b32 v9, 8, v128
    v_add_u32 v128, 9, v132
    v_mul_u32_u24 v128, 52, v128
    v_lshrrev_b32 v5, 8, v128
    v_add_u32 v128, 9, v130
    v_mul_u32_u24 v128, 52, v128
    v_lshrrev_b32 v10, 8, v128
    v_add_u32 v128, 13, v132
    v_mul_u32_u24 v128, 52, v128
    v_lshrrev_b32 v6, 8, v128
    v_add_u32 v128, 13, v130
    v_mul_u32_u24 v128, 52, v128
    v_lshrrev_b32 v11, 8, v128
    v_add_u32 v128, 17, v132
    v_mul_u32_u24 v128, 52, v128
    v_lshrrev_b32 v7, 8, v128
    v_add_u32 v128, 17, v130
    v_mul_u32_u24 v128, 52, v128
    v_lshrrev_b32 v12, 8, v128
    v_add_u32 v128, 21, v132
    v_mul_u32_u24 v128, 52, v128
    v_lshrrev_b32 v8, 8, v128
    v_add_u32 v128, 21, v130
    v_mul_u32_u24 v128, 52, v128
    v_lshrrev_b32 v13, 8, v128
    v_lshlrev_b32 v128, 3, v133
    v_add_u32 v128, 65536, v128
    v_lshlrev_b32 v129, 3, v132
    v_add_u32 v129, 73216, v129
    s_waitcnt vmcnt(10)
    v_pk_add_f32 v[16:17], v[16:17], v[48:49]
    v_pk_add_f32 v[18:19], v[18:19], v[50:51]
    v_pk_add_f32 v[20:21], v[20:21], v[52:53]
    v_pk_add_f32 v[22:23], v[22:23], v[54:55]
    v_pk_add_f32 v[24:25], v[24:25], v[56:57]
    v_pk_add_f32 v[26:27], v[26:27], v[58:59]
    v_pk_add_f32 v[28:29], v[28:29], v[60:61]
    v_pk_add_f32 v[30:31], v[30:31], v[62:63]
    v_pk_add_f32 v[32:33], v[32:33], v[64:65]
    v_pk_add_f32 v[34:35], v[34:35], v[66:67]
    v_pk_add_f32 v[36:37], v[36:37], v[68:69]
    v_pk_add_f32 v[38:39], v[38:39], v[70:71]
    v_pk_add_f32 v[40:41], v[40:41], v[72:73]
    v_pk_add_f32 v[42:43], v[42:43], v[74:75]
    v_pk_add_f32 v[44:45], v[44:45], v[76:77]
    v_pk_add_f32 v[46:47], v[46:47], v[78:79]
    v_pk_add_f32 v[16:17], v[16:17], v[32:33]
    v_pk_add_f32 v[18:19], v[18:19], v[34:35]
    v_pk_add_f32 v[20:21], v[20:21], v[36:37]
    v_pk_add_f32 v[22:23], v[22:23], v[38:39]
    v_pk_add_f32 v[24:25], v[24:25], v[40:41]
    v_pk_add_f32 v[26:27], v[26:27], v[42:43]
    v_pk_add_f32 v[28:29], v[28:29], v[44:45]
    v_pk_add_f32 v[30:31], v[30:31], v[46:47]
    v_pk_add_f32 v[16:17], v[16:17], v[24:25]
    v_pk_add_f32 v[18:19], v[18:19], v[26:27]
    v_pk_add_f32 v[20:21], v[20:21], v[28:29]
    v_pk_add_f32 v[22:23], v[22:23], v[30:31]
    v_pk_add_f32 v[16:17], v[16:17], v[20:21]
    v_pk_add_f32 v[18:19], v[18:19], v[22:23]
    v_cvt_pk_bf16_f32 v140, v16, v17
    v_cvt_pk_bf16_f32 v141, v18, v19
    ds_write_b64 v15, v[140:141]
    s_waitcnt lgkmcnt(0)
    s_barrier
    ds_read_b64 v[140:141], v129 offset:0
    ds_read_b64 v[142:143], v129 offset:32
    ds_read_b64 v[144:145], v129 offset:64
    ds_read_b64 v[146:147], v129 offset:96
    ds_read_b64 v[148:149], v129 offset:128
    ds_read_b64 v[16:17], v128 offset:512
    ds_read_b64 v[18:19], v128 offset:1536
    ds_read_b64 v[20:21], v128 offset:1024
    ds_read_b64 v[22:23], v128 offset:2048
    ds_read_b64 v[24:25], v128 offset:3072
    ds_read_b64 v[30:31], v128 offset:2560
    ds_read_b64 v[32:33], v128 offset:3584
    ds_read_b64 v[34:35], v128 offset:4608
    s_waitcnt lgkmcnt(4)
    ds_read_b64 v[36:37], v128 offset:4096
    ds_read_b64 v[38:39], v128 offset:5120
    ds_read_b64 v[40:41], v128 offset:6144
    ds_read_b64 v[46:47], v128 offset:5632
    ds_read_b64 v[48:49], v128 offset:6656
    s_lshr_b32 s57, s62, 1
    s_mul_i32 s57, s57, 5120
    s_mul_i32 s58, s61, 96256
    s_add_u32 s58, s58, s57
    s_and_b32 s57, s62, 1
    s_lshl_b32 s60, s57, 11
    v_add_u32 v14, s60, v1
    s_lshl_b32 s60, s57, 3
    s_add_u32 s60, s60, 4096
    v_add_u32 v15, s60, v1
    s_waitcnt lgkmcnt(0)
    v_cmp_eq_u32 vcc, v4, v9
    s_nop 1
    v_cndmask_b32 v16, 0, v16, vcc
    v_cndmask_b32 v17, 0, v17, vcc
    v_cndmask_b32 v52, 0, v140, vcc
    v_cndmask_b32 v53, 0, v141, vcc
    v_cmp_eq_u32 vcc, v5, v9
    s_nop 1
    v_cndmask_b32 v18, 0, v18, vcc
    v_cndmask_b32 v19, 0, v19, vcc
    v_cndmask_b32 v54, 0, v142, vcc
    v_cndmask_b32 v55, 0, v143, vcc
    v_cmp_eq_u32 vcc, v4, v10
    s_nop 1
    v_cndmask_b32 v20, 0, v20, vcc
    v_cndmask_b32 v21, 0, v21, vcc
    v_cndmask_b32 v56, 0, v140, vcc
    v_cndmask_b32 v57, 0, v141, vcc
    v_cmp_eq_u32 vcc, v5, v10
    s_nop 1
    v_cndmask_b32 v22, 0, v22, vcc
    v_cndmask_b32 v23, 0, v23, vcc
    v_cndmask_b32 v58, 0, v142, vcc
    v_cndmask_b32 v59, 0, v143, vcc
    v_cmp_eq_u32 vcc, v6, v10
    s_nop 1
    v_cndmask_b32 v24, 0, v24, vcc
    v_cndmask_b32 v25, 0, v25, vcc
    v_cndmask_b32 v60, 0, v144, vcc
    v_cndmask_b32 v61, 0, v145, vcc
    v_mov_b32 v26, 0
    v_mov_b32 v27, 0
    v_mov_b32 v62, 0
    v_mov_b32 v63, 0
    v_mov_b32 v28, 0
    v_mov_b32 v29, 0
    v_mov_b32 v64, 0
    v_mov_b32 v65, 0
    v_cmp_eq_u32 vcc, v5, v11
    s_nop 1
    v_cndmask_b32 v30, 0, v30, vcc
    v_cndmask_b32 v31, 0, v31, vcc
    v_cndmask_b32 v66, 0, v142, vcc
    v_cndmask_b32 v67, 0, v143, vcc
    v_cmp_eq_u32 vcc, v6, v11
    s_nop 1
    v_cndmask_b32 v32, 0, v32, vcc
    v_cndmask_b32 v33, 0, v33, vcc
    v_cndmask_b32 v68, 0, v144, vcc
    v_cndmask_b32 v69, 0, v145, vcc
    v_cmp_eq_u32 vcc, v7, v11
    s_nop 1
    v_cndmask_b32 v34, 0, v34, vcc
    v_cndmask_b32 v35, 0, v35, vcc
    v_cndmask_b32 v70, 0, v146, vcc
    v_cndmask_b32 v71, 0, v147, vcc
    v_cmp_eq_u32 vcc, v6, v12
    s_nop 1
    v_cndmask_b32 v36, 0, v36, vcc
    v_cndmask_b32 v37, 0, v37, vcc
    v_cndmask_b32 v72, 0, v144, vcc
    v_cndmask_b32 v73, 0, v145, vcc
    v_cmp_eq_u32 vcc, v7, v12
    s_nop 1
    v_cndmask_b32 v38, 0, v38, vcc
    v_cndmask_b32 v39, 0, v39, vcc
    v_cndmask_b32 v74, 0, v146, vcc
    v_cndmask_b32 v75, 0, v147, vcc
    v_cmp_eq_u32 vcc, v8, v12
    s_nop 1
    v_cndmask_b32 v40, 0, v40, vcc
    v_cndmask_b32 v41, 0, v41, vcc
    v_cndmask_b32 v76, 0, v148, vcc
    v_cndmask_b32 v77, 0, v149, vcc
    v_mov_b32 v42, 0
    v_mov_b32 v43, 0
    v_mov_b32 v78, 0
    v_mov_b32 v79, 0
    v_mov_b32 v44, 0
    v_mov_b32 v45, 0
    v_mov_b32 v80, 0
    v_mov_b32 v81, 0
    v_cmp_eq_u32 vcc, v7, v13
    s_nop 1
    v_cndmask_b32 v46, 0, v46, vcc
    v_cndmask_b32 v47, 0, v47, vcc
    v_cndmask_b32 v82, 0, v146, vcc
    v_cndmask_b32 v83, 0, v147, vcc
    v_cmp_eq_u32 vcc, v8, v13
    s_nop 1
    v_cndmask_b32 v48, 0, v48, vcc
    v_cndmask_b32 v49, 0, v49, vcc
    v_cndmask_b32 v84, 0, v148, vcc
    v_cndmask_b32 v85, 0, v149, vcc
    v_mov_b32 v50, 0
    v_mov_b32 v51, 0
    v_mov_b32 v86, 0
    v_mov_b32 v87, 0
    v_mov_b32 v138, 0
    v_mov_b32 v139, 0
    s_waitcnt vmcnt(0)
    v_mov_b32 v128, v88
    v_mov_b32 v129, v89
    v_mov_b32 v130, v92
    v_mov_b32 v131, v93
    v_mov_b32 v132, v96
    v_mov_b32 v133, v97
    v_mov_b32 v134, v100
    v_mov_b32 v135, v101
    v_mov_b32 v136, v104
    v_mov_b32 v137, v105
    v_mfma_f32_16x16x32_bf16 v[140:143], v[52:55], v[128:131], 0
    v_mfma_f32_16x16x32_bf16 v[144:147], v[56:59], v[128:131], 0
    v_mfma_f32_16x16x32_bf16 v[144:147], v[60:63], v[132:135], v[144:147]
    v_mfma_f32_16x16x32_bf16 v[148:151], v[64:67], v[128:131], 0
    v_mfma_f32_16x16x32_bf16 v[148:151], v[68:71], v[132:135], v[148:151]
    v_mfma_f32_16x16x32_bf16 v[152:155], v[72:75], v[132:135], 0
    v_mfma_f32_16x16x32_bf16 v[152:155], v[76:79], v[136:139], v[152:155]
    v_mfma_f32_16x16x32_bf16 v[156:159], v[80:83], v[132:135], 0
    v_mfma_f32_16x16x32_bf16 v[156:159], v[84:87], v[136:139], v[156:159]
    v_add_f32 v4, s76, v140
    s_nop 0
    v_add_f32 v5, s76, v144
    s_nop 0
    v_add_f32 v6, s76, v148
    s_nop 0
    v_add_f32 v7, s76, v152
    s_nop 0
    v_add_f32 v8, s76, v156
    v_mfma_f32_16x16x32_bf16 v[140:143], v[16:19], v[128:131], 0
    v_mfma_f32_16x16x32_bf16 v[144:147], v[20:23], v[128:131], 0
    v_mfma_f32_16x16x32_bf16 v[144:147], v[24:27], v[132:135], v[144:147]
    v_mfma_f32_16x16x32_bf16 v[148:151], v[28:31], v[128:131], 0
    v_mfma_f32_16x16x32_bf16 v[148:151], v[32:35], v[132:135], v[148:151]
    v_mfma_f32_16x16x32_bf16 v[152:155], v[36:39], v[132:135], 0
    v_mfma_f32_16x16x32_bf16 v[152:155], v[40:43], v[136:139], v[152:155]
    v_mfma_f32_16x16x32_bf16 v[156:159], v[44:47], v[132:135], 0
    v_mfma_f32_16x16x32_bf16 v[156:159], v[48:51], v[136:139], v[156:159]
    v_rcp_f32 v4, v4
    v_rcp_f32 v5, v5
    v_rcp_f32 v6, v6
    v_rcp_f32 v7, v7
    v_rcp_f32 v8, v8
    v_mul_f32 v140, v140, v4
    v_mul_f32 v141, v141, v4
    v_mul_f32 v142, v142, v4
    v_mul_f32 v143, v143, v4
    v_cvt_pk_bf16_f32 v140, v140, v141
    v_cvt_pk_bf16_f32 v141, v142, v143
    v_mul_f32 v144, v144, v5
    v_mul_f32 v145, v145, v5
    v_mul_f32 v146, v146, v5
    v_mul_f32 v147, v147, v5
    v_cvt_pk_bf16_f32 v142, v144, v145
    v_cvt_pk_bf16_f32 v143, v146, v147
    v_mul_f32 v148, v148, v6
    v_mul_f32 v149, v149, v6
    v_mul_f32 v150, v150, v6
    v_mul_f32 v151, v151, v6
    v_cvt_pk_bf16_f32 v144, v148, v149
    v_cvt_pk_bf16_f32 v145, v150, v151
    v_mul_f32 v152, v152, v7
    v_mul_f32 v153, v153, v7
    v_mul_f32 v154, v154, v7
    v_mul_f32 v155, v155, v7
    v_cvt_pk_bf16_f32 v146, v152, v153
    v_cvt_pk_bf16_f32 v147, v154, v155
    v_mul_f32 v156, v156, v8
    v_mul_f32 v157, v157, v8
    v_mul_f32 v158, v158, v8
    v_mul_f32 v159, v159, v8
    v_cvt_pk_bf16_f32 v148, v156, v157
    v_cvt_pk_bf16_f32 v149, v158, v159
    buffer_store_dwordx4 v[140:143], v14, s[44:47], s58 offen sc1
    buffer_store_dwordx4 v[144:147], v14, s[44:47], s58 offen offset:1024 sc1
    buffer_store_dwordx2 v[148:149], v15, s[44:47], s58 offen sc1
    s_add_u32 s58, s58, 48128
    v_mov_b32 v128, v90
    v_mov_b32 v129, v91
    v_mov_b32 v130, v94
    v_mov_b32 v131, v95
    v_mov_b32 v132, v98
    v_mov_b32 v133, v99
    v_mov_b32 v134, v102
    v_mov_b32 v135, v103
    v_mov_b32 v136, v106
    v_mov_b32 v137, v107
    v_mfma_f32_16x16x32_bf16 v[140:143], v[52:55], v[128:131], 0
    v_mfma_f32_16x16x32_bf16 v[144:147], v[56:59], v[128:131], 0
    v_mfma_f32_16x16x32_bf16 v[144:147], v[60:63], v[132:135], v[144:147]
    v_mfma_f32_16x16x32_bf16 v[148:151], v[64:67], v[128:131], 0
    v_mfma_f32_16x16x32_bf16 v[148:151], v[68:71], v[132:135], v[148:151]
    v_mfma_f32_16x16x32_bf16 v[152:155], v[72:75], v[132:135], 0
    v_mfma_f32_16x16x32_bf16 v[152:155], v[76:79], v[136:139], v[152:155]
    v_mfma_f32_16x16x32_bf16 v[156:159], v[80:83], v[132:135], 0
    v_mfma_f32_16x16x32_bf16 v[156:159], v[84:87], v[136:139], v[156:159]
    v_add_f32 v4, s76, v140
    s_nop 0
    v_add_f32 v5, s76, v144
    s_nop 0
    v_add_f32 v6, s76, v148
    s_nop 0
    v_add_f32 v7, s76, v152
    s_nop 0
    v_add_f32 v8, s76, v156
    v_mfma_f32_16x16x32_bf16 v[140:143], v[16:19], v[128:131], 0
    v_mfma_f32_16x16x32_bf16 v[144:147], v[20:23], v[128:131], 0
    v_mfma_f32_16x16x32_bf16 v[144:147], v[24:27], v[132:135], v[144:147]
    v_mfma_f32_16x16x32_bf16 v[148:151], v[28:31], v[128:131], 0
    v_mfma_f32_16x16x32_bf16 v[148:151], v[32:35], v[132:135], v[148:151]
    v_mfma_f32_16x16x32_bf16 v[152:155], v[36:39], v[132:135], 0
    v_mfma_f32_16x16x32_bf16 v[152:155], v[40:43], v[136:139], v[152:155]
    v_mfma_f32_16x16x32_bf16 v[156:159], v[44:47], v[132:135], 0
    v_mfma_f32_16x16x32_bf16 v[156:159], v[48:51], v[136:139], v[156:159]
    v_rcp_f32 v4, v4
    v_rcp_f32 v5, v5
    v_rcp_f32 v6, v6
    v_rcp_f32 v7, v7
    v_rcp_f32 v8, v8
    v_mul_f32 v140, v140, v4
    v_mul_f32 v141, v141, v4
    v_mul_f32 v142, v142, v4
    v_mul_f32 v143, v143, v4
    v_cvt_pk_bf16_f32 v140, v140, v141
    v_cvt_pk_bf16_f32 v141, v142, v143
    v_mul_f32 v144, v144, v5
    v_mul_f32 v145, v145, v5
    v_mul_f32 v146, v146, v5
    v_mul_f32 v147, v147, v5
    v_cvt_pk_bf16_f32 v142, v144, v145
    v_cvt_pk_bf16_f32 v143, v146, v147
    v_mul_f32 v148, v148, v6
    v_mul_f32 v149, v149, v6
    v_mul_f32 v150, v150, v6
    v_mul_f32 v151, v151, v6
    v_cvt_pk_bf16_f32 v144, v148, v149
    v_cvt_pk_bf16_f32 v145, v150, v151
    v_mul_f32 v152, v152, v7
    v_mul_f32 v153, v153, v7
    v_mul_f32 v154, v154, v7
    v_mul_f32 v155, v155, v7
    v_cvt_pk_bf16_f32 v146, v152, v153
    v_cvt_pk_bf16_f32 v147, v154, v155
    v_mul_f32 v156, v156, v8
    v_mul_f32 v157, v157, v8
    v_mul_f32 v158, v158, v8
    v_mul_f32 v159, v159, v8
    v_cvt_pk_bf16_f32 v148, v156, v157
    v_cvt_pk_bf16_f32 v149, v158, v159
    buffer_store_dwordx4 v[140:143], v14, s[44:47], s58 offen sc1
    buffer_store_dwordx4 v[144:147], v14, s[44:47], s58 offen offset:1024 sc1
    buffer_store_dwordx2 v[148:149], v15, s[44:47], s58 offen sc1
    s_add_u32 s58, s58, 48128
    v_mov_b32 v128, v108
    v_mov_b32 v129, v109
    v_mov_b32 v130, v112
    v_mov_b32 v131, v113
    v_mov_b32 v132, v116
    v_mov_b32 v133, v117
    v_mov_b32 v134, v120
    v_mov_b32 v135, v121
    v_mov_b32 v136, v124
    v_mov_b32 v137, v125
    v_mfma_f32_16x16x32_bf16 v[140:143], v[52:55], v[128:131], 0
    v_mfma_f32_16x16x32_bf16 v[144:147], v[56:59], v[128:131], 0
    v_mfma_f32_16x16x32_bf16 v[144:147], v[60:63], v[132:135], v[144:147]
    v_mfma_f32_16x16x32_bf16 v[148:151], v[64:67], v[128:131], 0
    v_mfma_f32_16x16x32_bf16 v[148:151], v[68:71], v[132:135], v[148:151]
    v_mfma_f32_16x16x32_bf16 v[152:155], v[72:75], v[132:135], 0
    v_mfma_f32_16x16x32_bf16 v[152:155], v[76:79], v[136:139], v[152:155]
    v_mfma_f32_16x16x32_bf16 v[156:159], v[80:83], v[132:135], 0
    v_mfma_f32_16x16x32_bf16 v[156:159], v[84:87], v[136:139], v[156:159]
    v_add_f32 v4, s76, v140
    s_nop 0
    v_add_f32 v5, s76, v144
    s_nop 0
    v_add_f32 v6, s76, v148
    s_nop 0
    v_add_f32 v7, s76, v152
    s_nop 0
    v_add_f32 v8, s76, v156
    v_mfma_f32_16x16x32_bf16 v[140:143], v[16:19], v[128:131], 0
    v_mfma_f32_16x16x32_bf16 v[144:147], v[20:23], v[128:131], 0
    v_mfma_f32_16x16x32_bf16 v[144:147], v[24:27], v[132:135], v[144:147]
    v_mfma_f32_16x16x32_bf16 v[148:151], v[28:31], v[128:131], 0
    v_mfma_f32_16x16x32_bf16 v[148:151], v[32:35], v[132:135], v[148:151]
    v_mfma_f32_16x16x32_bf16 v[152:155], v[36:39], v[132:135], 0
    v_mfma_f32_16x16x32_bf16 v[152:155], v[40:43], v[136:139], v[152:155]
    v_mfma_f32_16x16x32_bf16 v[156:159], v[44:47], v[132:135], 0
    v_mfma_f32_16x16x32_bf16 v[156:159], v[48:51], v[136:139], v[156:159]
    v_rcp_f32 v4, v4
    v_rcp_f32 v5, v5
    v_rcp_f32 v6, v6
    v_rcp_f32 v7, v7
    v_rcp_f32 v8, v8
    v_mul_f32 v140, v140, v4
    v_mul_f32 v141, v141, v4
    v_mul_f32 v142, v142, v4
    v_mul_f32 v143, v143, v4
    v_cvt_pk_bf16_f32 v140, v140, v141
    v_cvt_pk_bf16_f32 v141, v142, v143
    v_mul_f32 v144, v144, v5
    v_mul_f32 v145, v145, v5
    v_mul_f32 v146, v146, v5
    v_mul_f32 v147, v147, v5
    v_cvt_pk_bf16_f32 v142, v144, v145
    v_cvt_pk_bf16_f32 v143, v146, v147
    v_mul_f32 v148, v148, v6
    v_mul_f32 v149, v149, v6
    v_mul_f32 v150, v150, v6
    v_mul_f32 v151, v151, v6
    v_cvt_pk_bf16_f32 v144, v148, v149
    v_cvt_pk_bf16_f32 v145, v150, v151
    v_mul_f32 v152, v152, v7
    v_mul_f32 v153, v153, v7
    v_mul_f32 v154, v154, v7
    v_mul_f32 v155, v155, v7
    v_cvt_pk_bf16_f32 v146, v152, v153
    v_cvt_pk_bf16_f32 v147, v154, v155
    v_mul_f32 v156, v156, v8
    v_mul_f32 v157, v157, v8
    v_mul_f32 v158, v158, v8
    v_mul_f32 v159, v159, v8
    v_cvt_pk_bf16_f32 v148, v156, v157
    v_cvt_pk_bf16_f32 v149, v158, v159
    buffer_store_dwordx4 v[140:143], v14, s[44:47], s58 offen sc1
    buffer_store_dwordx4 v[144:147], v14, s[44:47], s58 offen offset:1024 sc1
    buffer_store_dwordx2 v[148:149], v15, s[44:47], s58 offen sc1
    s_add_u32 s58, s58, 48128
    v_mov_b32 v128, v110
    v_mov_b32 v129, v111
    v_mov_b32 v130, v114
    v_mov_b32 v131, v115
    v_mov_b32 v132, v118
    v_mov_b32 v133, v119
    v_mov_b32 v134, v122
    v_mov_b32 v135, v123
    v_mov_b32 v136, v126
    v_mov_b32 v137, v127
    v_mfma_f32_16x16x32_bf16 v[140:143], v[52:55], v[128:131], 0
    v_mfma_f32_16x16x32_bf16 v[144:147], v[56:59], v[128:131], 0
    v_mfma_f32_16x16x32_bf16 v[144:147], v[60:63], v[132:135], v[144:147]
    v_mfma_f32_16x16x32_bf16 v[148:151], v[64:67], v[128:131], 0
    v_mfma_f32_16x16x32_bf16 v[148:151], v[68:71], v[132:135], v[148:151]
    v_mfma_f32_16x16x32_bf16 v[152:155], v[72:75], v[132:135], 0
    v_mfma_f32_16x16x32_bf16 v[152:155], v[76:79], v[136:139], v[152:155]
    v_mfma_f32_16x16x32_bf16 v[156:159], v[80:83], v[132:135], 0
    v_mfma_f32_16x16x32_bf16 v[156:159], v[84:87], v[136:139], v[156:159]
    v_add_f32 v4, s76, v140
    s_nop 0
    v_add_f32 v5, s76, v144
    s_nop 0
    v_add_f32 v6, s76, v148
    s_nop 0
    v_add_f32 v7, s76, v152
    s_nop 0
    v_add_f32 v8, s76, v156
    v_mfma_f32_16x16x32_bf16 v[140:143], v[16:19], v[128:131], 0
    v_mfma_f32_16x16x32_bf16 v[144:147], v[20:23], v[128:131], 0
    v_mfma_f32_16x16x32_bf16 v[144:147], v[24:27], v[132:135], v[144:147]
    v_mfma_f32_16x16x32_bf16 v[148:151], v[28:31], v[128:131], 0
    v_mfma_f32_16x16x32_bf16 v[148:151], v[32:35], v[132:135], v[148:151]
    v_mfma_f32_16x16x32_bf16 v[152:155], v[36:39], v[132:135], 0
    v_mfma_f32_16x16x32_bf16 v[152:155], v[40:43], v[136:139], v[152:155]
    v_mfma_f32_16x16x32_bf16 v[156:159], v[44:47], v[132:135], 0
    v_mfma_f32_16x16x32_bf16 v[156:159], v[48:51], v[136:139], v[156:159]
    v_rcp_f32 v4, v4
    v_rcp_f32 v5, v5
    v_rcp_f32 v6, v6
    v_rcp_f32 v7, v7
    v_rcp_f32 v8, v8
    v_mul_f32 v140, v140, v4
    v_mul_f32 v141, v141, v4
    v_mul_f32 v142, v142, v4
    v_mul_f32 v143, v143, v4
    v_cvt_pk_bf16_f32 v140, v140, v141
    v_cvt_pk_bf16_f32 v141, v142, v143
    v_mul_f32 v144, v144, v5
    v_mul_f32 v145, v145, v5
    v_mul_f32 v146, v146, v5
    v_mul_f32 v147, v147, v5
    v_cvt_pk_bf16_f32 v142, v144, v145
    v_cvt_pk_bf16_f32 v143, v146, v147
    v_mul_f32 v148, v148, v6
    v_mul_f32 v149, v149, v6
    v_mul_f32 v150, v150, v6
    v_mul_f32 v151, v151, v6
    v_cvt_pk_bf16_f32 v144, v148, v149
    v_cvt_pk_bf16_f32 v145, v150, v151
    v_mul_f32 v152, v152, v7
    v_mul_f32 v153, v153, v7
    v_mul_f32 v154, v154, v7
    v_mul_f32 v155, v155, v7
    v_cvt_pk_bf16_f32 v146, v152, v153
    v_cvt_pk_bf16_f32 v147, v154, v155
    v_mul_f32 v156, v156, v8
    v_mul_f32 v157, v157, v8
    v_mul_f32 v158, v158, v8
    v_mul_f32 v159, v159, v8
    v_cvt_pk_bf16_f32 v148, v156, v157
    v_cvt_pk_bf16_f32 v149, v158, v159
    buffer_store_dwordx4 v[140:143], v14, s[44:47], s58 offen sc1
    buffer_store_dwordx4 v[144:147], v14, s[44:47], s58 offen offset:1024 sc1
    buffer_store_dwordx2 v[148:149], v15, s[44:47], s58 offen sc1
    s_add_u32 s58, s58, 48128
    s_waitcnt vmcnt(0)
    s_barrier
    s_nop 0
    s_cmp_lg_u32 s52, 4
    s_cbranch_scc1 k2s_171
    v_lshlrev_b32 v3, 3, v1
    v_mov_b32 v14, 1
    s_mov_b32 exec_hi, 0
    buffer_atomic_add v14, v3, s[48:51], 0 offen offset:64 sc1
    s_mov_b32 exec_hi, -1
k2s_171:
    s_barrier
    s_lshl_b32 s66, s55, 2
    s_add_u32 s66, s66, s53
    s_mul_i32 s66, s66, 47
    s_add_u32 s66, s66, s54
    s_lshl_b32 s66, s66, 10
    buffer_load_dwordx4 v[12:15], v1, s[44:47], s66 offen offset:0
    buffer_load_dwordx4 v[16:19], v1, s[44:47], s66 offen offset:2048
    s_add_u32 s66, s66, 4096
    buffer_load_dwordx4 v[20:23], v1, s[44:47], s66 offen offset:0
    buffer_load_dwordx4 v[24:27], v1, s[44:47], s66 offen offset:2048
    s_add_u32 s66, s66, 4096
    buffer_load_dwordx4 v[28:31], v1, s[44:47], s66 offen offset:0
    buffer_load_dwordx4 v[32:35], v1, s[44:47], s66 offen offset:2048
    s_add_u32 s66, s66, 4096
    buffer_load_dwordx4 v[36:39], v1, s[44:47], s66 offen offset:0
    buffer_load_dwordx4 v[40:43], v1, s[44:47], s66 offen offset:2048
    s_add_u32 s66, s66, 4096
    buffer_load_dwordx4 v[44:47], v1, s[44:47], s66 offen offset:0
    buffer_load_dwordx4 v[48:51], v1, s[44:47], s66 offen offset:2048
    s_add_u32 s66, s66, 4096
    s_waitcnt vmcnt(0)
parallel_sum__linear_attn_block__mixer_gmlp__prompt_kernel_last:
    s_branch k3comp_94

.section .rodata,"a"
.p2align 6
.amdhsa_kernel parallel_sum__linear_attn_block__mixer_gmlp__prompt_kernel
  .amdhsa_next_free_vgpr 168
  .amdhsa_next_free_sgpr 102
  .amdhsa_accum_offset 168
  .amdhsa_group_segment_fixed_size 0
  .amdhsa_kernarg_size 88
  .amdhsa_user_sgpr_count 2
  .amdhsa_user_sgpr_kernarg_segment_ptr 1
  .amdhsa_system_sgpr_workgroup_id_x 1
.end_amdhsa_kernel
```
